```python
import torch

def _softmax(x, axis=-1):
    return torch.softmax(x, dim=axis)
def _gelu(x):
    return torch.nn.functional.gelu(x, approximate="tanh")
def _silu(x):
    return torch.nn.functional.silu(x)
def _sigmoid(x):
    return torch.sigmoid(x)
def _layernorm(x, axis=-1, eps=1e-5):
    m = x.mean(dim=axis, keepdim=True)
    v = x.var(dim=axis, keepdim=True, unbiased=False)
    return (x - m) / torch.sqrt(v + eps)
def _scatter_add(tgt, idx, src, axis=0):
    return tgt.clone().index_add_(axis, idx, src)
def _segment_sum(src, seg, n):
    out = torch.zeros((n,) + src.shape[1:], dtype=src.dtype)
    return out.index_add_(0, seg, src)
def _pad(x, pw):
    flat = tuple(v for pair in reversed(pw) for v in pair)
    return torch.nn.functional.pad(x, flat)

kernel_name = 'standalone__gqa_softmax__near_ridge'

def setup_inputs():

    _w = (lambda a: (lambda t: t.to(torch.bfloat16) if t.is_floating_point() else t)(torch.as_tensor(a)))
    B, Hq, Hkv, Sq, Sk, D = 8, 16, 8, 256, 512, 256
    return {
        "q": _w((lambda *s: torch.randn(*s, dtype=torch.bfloat16) * 0.8)(B, Hq, Sq, D)),
        "k": _w((lambda *s: torch.randn(*s, dtype=torch.bfloat16) * 0.8)(B, Hkv, Sk, D)),
        "v": _w((lambda *s: torch.randn(*s, dtype=torch.bfloat16) * 0.05)(B, Hkv, Sk, D)),
    }

def reference(q, k, v):
    B, Hq, Sq, D = q.shape
    Hkv = k.shape[1]
    rep = Hq // Hkv
    k = (lambda x, n, axis: torch.repeat_interleave(x, n, dim=axis))(k, rep, axis=1)
    v = (lambda x, n, axis: torch.repeat_interleave(x, n, dim=axis))(v, rep, axis=1)
    scale = D ** -0.5
    scores = torch.einsum("bhqd,bhkd->bhqk", q, k) * scale
    p = _softmax(scores, axis=-1)
    return torch.einsum("bhqk,bhkd->bhqd", p, v)
```

```asm
; @launch grid=(256,1,1) block=(512,1,1) lds=163840
.amdgcn_target "amdgcn-amd-amdhsa--gfx950"
.text
.globl standalone__gqa_softmax__near_ridge_kernel
.p2align 8
.type standalone__gqa_softmax__near_ridge_kernel,@function
standalone__gqa_softmax__near_ridge_kernel:
    s_load_dwordx4 s[4:7], s[0:1], 0
    s_load_dwordx4 s[8:11], s[0:1], 16
    s_cmp_ge_u32 s2, 256
    s_cbranch_scc1 L_end
    s_lshr_b32 s13, s2, 3
    v_lshrrev_b32 v48, 6, v0
    v_and_b32 v1, 63, v0
    s_getpc_b64 s[46:47]
L_pc:
    s_sub_u32 s46, s46, L_pc-standalone__gqa_softmax__near_ridge_kernel
    s_subb_u32 s47, s47, 0
    s_and_b32 s38, s13, 3
    s_lshl_b32 s38, s38, 13
    v_lshl_add_u32 v12, v0, 4, s38
    v_min_u32 v12, L_codeend-standalone__gqa_softmax__near_ridge_kernel-4, v12
    v_mov_b32 v13, s47
    v_add_co_u32 v12, vcc, s46, v12
    s_cmp_ge_u32 s13, 32
    s_cbranch_scc1 L_nocpf
    v_addc_co_u32 v13, vcc, 0, v13, vcc
    global_load_dword v23, v[12:13], off
L_nocpf:
    v_readfirstlane_b32 s3, v48
    s_and_b32 s12, s2, 7
    s_lshr_b32 s14, s13, 2
    s_lshl_b32 s12, s12, 3
    s_add_u32 s12, s12, s14
    s_and_b32 s34, s13, 3
    s_lshl_b32 s14, s12, 18
    s_lshl_b32 s15, s34, 16
    s_add_u32 s15, s15, s14
    s_and_b32 s35, s3, 3
    v_lshrrev_b32 v48, 3, v1
    v_lshlrev_b32 v48, 9, v48
    s_lshl_b32 s32, s35, 12
    v_add_u32 v48, s32, v48
    v_and_b32 v49, 7, v1
    v_lshrrev_b32 v50, 4, v1
    v_xor_b32 v51, v49, v50
    s_and_b32 s33, s3, 1
    s_lshl_b32 s33, s33, 2
    v_xor_b32 v51, s33, v51
    v_lshl_add_u32 v2, v51, 4, v48
    s_lshl_b32 s32, s35, 10
    s_mov_b32 s18, 65536
    s_mov_b32 s19, 0x20000
    s_mov_b32 s22, 262144
    s_mov_b32 s23, 0x20000
    s_mov_b32 s26, 262144
    s_mov_b32 s27, 0x20000
    s_mov_b32 s30, 65536
    s_mov_b32 s31, 0x20000
    s_lshl_b32 s38, s12, 7
    s_waitcnt lgkmcnt(0)
    s_add_u32 s16, s4, s15
    s_addc_u32 s17, s5, 0
    s_add_u32 s20, s6, s14
    s_addc_u32 s21, s7, 0
    s_add_u32 s24, s8, s14
    s_addc_u32 s25, s9, 0
    s_add_u32 s28, s10, s15
    s_addc_u32 s29, s11, 0
    s_and_b32 s4, s38, 0x180
    s_add_u32 s5, s38, 128
    s_and_b32 s5, s5, 0x180
    s_xor_b32 s6, s4, 0x100
    s_xor_b32 s7, s5, 0x100
    s_cmp_lt_u32 s3, 4
    s_cbranch_scc1 L_A
    s_add_u32 m0, s32, 0
    s_add_u32 s33, s4, 0
    buffer_load_dwordx4 v2, s[16:19], s33 offen nt lds
    s_add_u32 m0, s32, 4096
    s_add_u32 s33, s4, 16384
    buffer_load_dwordx4 v2, s[16:19], s33 offen nt lds
    s_add_u32 m0, s32, 8192
    s_add_u32 s33, s4, 32768
    buffer_load_dwordx4 v2, s[16:19], s33 offen nt lds
    s_add_u32 m0, s32, 12288
    s_add_u32 s33, s4, 49152
    buffer_load_dwordx4 v2, s[16:19], s33 offen nt lds
    s_add_u32 m0, s32, 16384
    s_add_u32 s33, s4, 0
    buffer_load_dwordx4 v2, s[20:23], s33 offen nt lds
    s_add_u32 m0, s32, 20480
    s_add_u32 s33, s4, 16384
    buffer_load_dwordx4 v2, s[20:23], s33 offen nt lds
    s_add_u32 m0, s32, 24576
    s_add_u32 s33, s4, 32768
    buffer_load_dwordx4 v2, s[20:23], s33 offen nt lds
    s_add_u32 m0, s32, 28672
    s_add_u32 s33, s4, 49152
    buffer_load_dwordx4 v2, s[20:23], s33 offen nt lds
    s_add_u32 m0, s32, 32768
    s_add_u32 s33, s4, 65536
    buffer_load_dwordx4 v2, s[20:23], s33 offen nt lds
    s_add_u32 m0, s32, 36864
    s_add_u32 s33, s4, 81920
    buffer_load_dwordx4 v2, s[20:23], s33 offen nt lds
    s_add_u32 m0, s32, 40960
    s_add_u32 s33, s4, 98304
    buffer_load_dwordx4 v2, s[20:23], s33 offen nt lds
    s_add_u32 m0, s32, 45056
    s_add_u32 s33, s4, 114688
    buffer_load_dwordx4 v2, s[20:23], s33 offen nt lds
    v_bfe_u32 v50, v1, 4, 1
    v_lshrrev_b32 v51, 5, v1
    v_lshl_or_b32 v50, v51, 2, v50
    v_xor_b32 v51, v49, v50
    v_lshl_add_u32 v3, v51, 4, v48
    v_and_b32 v48, 15, v1
    v_lshrrev_b32 v49, 4, v1
    v_lshrrev_b32 v50, 1, v48
    v_lshlrev_b32 v51, 7, v48
    s_lshl_b32 s39, s35, 12
    v_xor_b32 v52, v49, v50
    v_lshl_add_u32 v4, v52, 4, v51
    v_xor_b32 v5, 64, v4
    v_add_u32 v6, 0x10000, v4
    v_add_u32 v8, s39, v4
    v_add_u32 v10, s39, v6
    v_add_u32 v7, 0x10000, v5
    v_add_u32 v9, s39, v5
    v_add_u32 v11, s39, v7
    v_and_b32 v14, 7, v1
    v_lshlrev_b32 v14, 9, v14
    v_bfe_u32 v15, v1, 3, 1
    v_lshl_add_u32 v14, v15, 16, v14
    s_lshl_b32 s38, s34, 14
    s_add_u32 s38, s38, s39
    s_add_u32 s38, s38, 0x20000
    v_add_u32 v14, s38, v14
    v_subrev_u32 v16, 0x20000, v14
    s_lshl_b32 s38, s35, 11
    s_add_u32 s38, s38, 131072
    v_lshlrev_b32 v50, 4, v1
    v_add_u32 v25, s38, v50
    s_mov_b32 s42, 0x3db8aa3b
    s_waitcnt vmcnt(8)
    s_waitcnt vmcnt(4)
    s_barrier
    s_add_u32 m0, s32, 49152
    s_add_u32 s33, s5, 0
    buffer_load_dwordx4 v2, s[16:19], s33 offen nt lds
    s_add_u32 m0, s32, 53248
    s_add_u32 s33, s5, 16384
    buffer_load_dwordx4 v2, s[16:19], s33 offen nt lds
    s_add_u32 m0, s32, 57344
    s_add_u32 s33, s5, 32768
    buffer_load_dwordx4 v2, s[16:19], s33 offen nt lds
    s_add_u32 m0, s32, 61440
    s_add_u32 s33, s5, 49152
    buffer_load_dwordx4 v2, s[16:19], s33 offen nt lds
    ds_read_b128 v[64:67], v8 offset:0
    ds_read_b128 v[68:71], v8 offset:2048
    ds_read_b128 v[72:75], v9 offset:0
    ds_read_b128 v[76:79], v9 offset:2048
    s_waitcnt lgkmcnt(0)
    s_waitcnt vmcnt(4)
    s_barrier
    s_add_u32 m0, s32, 65536
    s_add_u32 s33, s5, 0
    buffer_load_dwordx4 v2, s[20:23], s33 offen nt lds
    s_add_u32 m0, s32, 69632
    s_add_u32 s33, s5, 16384
    buffer_load_dwordx4 v2, s[20:23], s33 offen nt lds
    s_add_u32 m0, s32, 73728
    s_add_u32 s33, s5, 32768
    buffer_load_dwordx4 v2, s[20:23], s33 offen nt lds
    s_add_u32 m0, s32, 77824
    s_add_u32 s33, s5, 49152
    buffer_load_dwordx4 v2, s[20:23], s33 offen nt lds
    s_add_u32 m0, s32, 81920
    s_add_u32 s33, s5, 65536
    buffer_load_dwordx4 v2, s[20:23], s33 offen nt lds
    s_add_u32 m0, s32, 86016
    s_add_u32 s33, s5, 81920
    buffer_load_dwordx4 v2, s[20:23], s33 offen nt lds
    s_add_u32 m0, s32, 90112
    s_add_u32 s33, s5, 98304
    buffer_load_dwordx4 v2, s[20:23], s33 offen nt lds
    s_add_u32 m0, s32, 94208
    s_add_u32 s33, s5, 114688
    buffer_load_dwordx4 v2, s[20:23], s33 offen nt lds
    s_waitcnt vmcnt(8)
    s_waitcnt vmcnt(4)
    s_barrier
    s_add_u32 m0, s32, 98304
    s_add_u32 s33, s6, 0
    buffer_load_dwordx4 v2, s[16:19], s33 offen nt lds
    s_add_u32 m0, s32, 102400
    s_add_u32 s33, s6, 16384
    buffer_load_dwordx4 v2, s[16:19], s33 offen nt lds
    s_add_u32 m0, s32, 106496
    s_add_u32 s33, s6, 32768
    buffer_load_dwordx4 v2, s[16:19], s33 offen nt lds
    s_add_u32 m0, s32, 110592
    s_add_u32 s33, s6, 49152
    buffer_load_dwordx4 v2, s[16:19], s33 offen nt lds
    ds_read_b128 v[80:83], v8 offset:49152
    ds_read_b128 v[84:87], v8 offset:51200
    ds_read_b128 v[88:91], v9 offset:49152
    ds_read_b128 v[92:95], v9 offset:51200
    s_waitcnt lgkmcnt(0)
    s_waitcnt vmcnt(4)
    s_barrier
    s_add_u32 m0, s32, 114688
    s_add_u32 s33, s6, 0
    buffer_load_dwordx4 v2, s[20:23], s33 offen nt lds
    s_add_u32 m0, s32, 118784
    s_add_u32 s33, s6, 16384
    buffer_load_dwordx4 v2, s[20:23], s33 offen nt lds
    s_add_u32 m0, s32, 122880
    s_add_u32 s33, s6, 32768
    buffer_load_dwordx4 v2, s[20:23], s33 offen nt lds
    s_add_u32 m0, s32, 126976
    s_add_u32 s33, s6, 49152
    buffer_load_dwordx4 v2, s[20:23], s33 offen nt lds
    s_add_u32 m0, s32, 0
    s_add_u32 s33, s6, 65536
    buffer_load_dwordx4 v2, s[20:23], s33 offen nt lds
    s_add_u32 m0, s32, 4096
    s_add_u32 s33, s6, 81920
    buffer_load_dwordx4 v2, s[20:23], s33 offen nt lds
    s_add_u32 m0, s32, 8192
    s_add_u32 s33, s6, 98304
    buffer_load_dwordx4 v2, s[20:23], s33 offen nt lds
    s_add_u32 m0, s32, 12288
    s_add_u32 s33, s6, 114688
    buffer_load_dwordx4 v2, s[20:23], s33 offen nt lds
    s_add_u32 m0, s32, 16384
    s_add_u32 s33, s7, 0
    buffer_load_dwordx4 v2, s[16:19], s33 offen nt lds
    s_add_u32 m0, s32, 20480
    s_add_u32 s33, s7, 16384
    buffer_load_dwordx4 v2, s[16:19], s33 offen nt lds
    s_add_u32 m0, s32, 24576
    s_add_u32 s33, s7, 32768
    buffer_load_dwordx4 v2, s[16:19], s33 offen nt lds
    s_add_u32 m0, s32, 28672
    s_add_u32 s33, s7, 49152
    buffer_load_dwordx4 v2, s[16:19], s33 offen nt lds
    s_waitcnt vmcnt(12)
    s_waitcnt vmcnt(8)
    s_barrier
    s_add_u32 m0, s32, 32768
    s_add_u32 s33, s7, 0
    buffer_load_dwordx4 v2, s[20:23], s33 offen nt lds
    s_add_u32 m0, s32, 36864
    s_add_u32 s33, s7, 16384
    buffer_load_dwordx4 v2, s[20:23], s33 offen nt lds
    s_add_u32 m0, s32, 40960
    s_add_u32 s33, s7, 32768
    buffer_load_dwordx4 v2, s[20:23], s33 offen nt lds
    s_add_u32 m0, s32, 45056
    s_add_u32 s33, s7, 49152
    buffer_load_dwordx4 v2, s[20:23], s33 offen nt lds
    ds_read_b128 v[96:99], v10 offset:32768
    ds_read_b128 v[100:103], v10 offset:34816
    ds_read_b128 v[104:107], v11 offset:32768
    ds_read_b128 v[108:111], v11 offset:34816
    s_waitcnt lgkmcnt(0)
    s_waitcnt vmcnt(8)
    s_barrier
    s_add_u32 m0, s32, 49152
    s_add_u32 s33, s7, 65536
    buffer_load_dwordx4 v2, s[20:23], s33 offen nt lds
    s_add_u32 m0, s32, 53248
    s_add_u32 s33, s7, 81920
    buffer_load_dwordx4 v2, s[20:23], s33 offen nt lds
    s_add_u32 m0, s32, 57344
    s_add_u32 s33, s7, 98304
    buffer_load_dwordx4 v2, s[20:23], s33 offen nt lds
    s_add_u32 m0, s32, 61440
    s_add_u32 s33, s7, 114688
    buffer_load_dwordx4 v2, s[20:23], s33 offen nt lds
    s_add_u32 m0, s32, 65536
    s_add_u32 s33, s4, 131072
    buffer_load_dwordx4 v2, s[20:23], s33 offen nt lds
    s_add_u32 m0, s32, 69632
    s_add_u32 s33, s4, 147456
    buffer_load_dwordx4 v2, s[20:23], s33 offen nt lds
    s_add_u32 m0, s32, 73728
    s_add_u32 s33, s4, 163840
    buffer_load_dwordx4 v2, s[20:23], s33 offen nt lds
    s_add_u32 m0, s32, 77824
    s_add_u32 s33, s4, 180224
    buffer_load_dwordx4 v2, s[20:23], s33 offen nt lds
    s_waitcnt vmcnt(12)
    s_waitcnt vmcnt(8)
    s_barrier
    s_add_u32 m0, s32, 81920
    s_add_u32 s33, s4, 196608
    buffer_load_dwordx4 v2, s[20:23], s33 offen nt lds
    s_add_u32 m0, s32, 86016
    s_add_u32 s33, s4, 212992
    buffer_load_dwordx4 v2, s[20:23], s33 offen nt lds
    s_add_u32 m0, s32, 90112
    s_add_u32 s33, s4, 229376
    buffer_load_dwordx4 v2, s[20:23], s33 offen nt lds
    s_add_u32 m0, s32, 94208
    s_add_u32 s33, s4, 245760
    buffer_load_dwordx4 v2, s[20:23], s33 offen nt lds
    ds_read_b128 v[112:115], v8 offset:16384
    ds_read_b128 v[116:119], v8 offset:18432
    ds_read_b128 v[120:123], v9 offset:16384
    ds_read_b128 v[124:127], v9 offset:18432
    s_waitcnt lgkmcnt(0)
    s_waitcnt vmcnt(8)
    s_barrier
    s_add_u32 m0, s32, 98304
    s_add_u32 s33, s5, 131072
    buffer_load_dwordx4 v2, s[20:23], s33 offen nt lds
    s_add_u32 m0, s32, 102400
    s_add_u32 s33, s5, 147456
    buffer_load_dwordx4 v2, s[20:23], s33 offen nt lds
    s_add_u32 m0, s32, 106496
    s_add_u32 s33, s5, 163840
    buffer_load_dwordx4 v2, s[20:23], s33 offen nt lds
    s_add_u32 m0, s32, 110592
    s_add_u32 s33, s5, 180224
    buffer_load_dwordx4 v2, s[20:23], s33 offen nt lds
    s_setprio 1
    s_waitcnt vmcnt(8)
    s_barrier
    ds_read_b128 v[20:23], v6 offset:0
    ds_read_b128 v[36:39], v6 offset:2048
    ds_read_b128 v[40:43], v6 offset:4096
    ds_read_b128 v[44:47], v6 offset:6144
    ds_read_b128 v[48:51], v6 offset:8192
    ds_read_b128 v[52:55], v6 offset:10240
    s_waitcnt lgkmcnt(4)
    v_mfma_f32_16x16x32_bf16 v[128:131], v[20:23], v[64:67], 0
    ds_read_b128 v[56:59], v6 offset:12288
    s_add_u32 m0, s32, 114688
    v_mfma_f32_16x16x32_bf16 v[136:139], v[20:23], v[68:71], 0
    s_add_u32 s33, s5, 196608
    v_mfma_f32_16x16x32_bf16 v[132:135], v[36:39], v[64:67], 0
    ds_read_b128 v[60:63], v6 offset:14336
    v_mfma_f32_16x16x32_bf16 v[140:143], v[36:39], v[68:71], 0
    buffer_load_dwordx4 v2, s[20:23], s33 offen nt lds
    s_waitcnt lgkmcnt(4)
    v_mfma_f32_16x16x32_bf16 v[144:147], v[40:43], v[64:67], 0
    ds_read_b128 v[20:23], v7 offset:0
    v_mfma_f32_16x16x32_bf16 v[152:155], v[40:43], v[68:71], 0
    v_mfma_f32_16x16x32_bf16 v[148:151], v[44:47], v[64:67], 0
    ds_read_b128 v[36:39], v7 offset:2048
    s_add_u32 m0, s32, 118784
    v_mfma_f32_16x16x32_bf16 v[156:159], v[44:47], v[68:71], 0
    s_waitcnt lgkmcnt(4)
    s_add_u32 s33, s5, 212992
    v_mfma_f32_16x16x32_bf16 v[160:163], v[48:51], v[64:67], 0
    ds_read_b128 v[40:43], v7 offset:4096
    v_mfma_f32_16x16x32_bf16 v[168:171], v[48:51], v[68:71], 0
    buffer_load_dwordx4 v2, s[20:23], s33 offen nt lds
    v_mfma_f32_16x16x32_bf16 v[164:167], v[52:55], v[64:67], 0
    ds_read_b128 v[44:47], v7 offset:6144
    v_mfma_f32_16x16x32_bf16 v[172:175], v[52:55], v[68:71], 0
    s_waitcnt lgkmcnt(4)
    v_mfma_f32_16x16x32_bf16 v[176:179], v[56:59], v[64:67], 0
    ds_read_b128 v[48:51], v7 offset:8192
    s_add_u32 m0, s32, 122880
    v_mfma_f32_16x16x32_bf16 v[184:187], v[56:59], v[68:71], 0
    s_add_u32 s33, s5, 229376
    v_mfma_f32_16x16x32_bf16 v[180:183], v[60:63], v[64:67], 0
    ds_read_b128 v[52:55], v7 offset:10240
    v_mfma_f32_16x16x32_bf16 v[188:191], v[60:63], v[68:71], 0
    buffer_load_dwordx4 v2, s[20:23], s33 offen nt lds
    s_waitcnt lgkmcnt(4)
    v_mfma_f32_16x16x32_bf16 v[128:131], v[20:23], v[72:75], v[128:131]
    ds_read_b128 v[56:59], v7 offset:12288
    v_mfma_f32_16x16x32_bf16 v[136:139], v[20:23], v[76:79], v[136:139]
    v_mfma_f32_16x16x32_bf16 v[132:135], v[36:39], v[72:75], v[132:135]
    ds_read_b128 v[60:63], v7 offset:14336
    s_add_u32 m0, s32, 126976
    v_mfma_f32_16x16x32_bf16 v[140:143], v[36:39], v[76:79], v[140:143]
    s_waitcnt lgkmcnt(4)
    s_add_u32 s33, s5, 245760
    v_mfma_f32_16x16x32_bf16 v[144:147], v[40:43], v[72:75], v[144:147]
    v_mfma_f32_16x16x32_bf16 v[152:155], v[40:43], v[76:79], v[152:155]
    buffer_load_dwordx4 v2, s[20:23], s33 offen nt lds
    s_waitcnt vmcnt(8)
    s_barrier
    ds_read_b128 v[20:23], v6 offset:16384
    v_mfma_f32_16x16x32_bf16 v[148:151], v[44:47], v[72:75], v[148:151]
    ds_read_b128 v[36:39], v6 offset:18432
    v_mfma_f32_16x16x32_bf16 v[156:159], v[44:47], v[76:79], v[156:159]
    s_waitcnt lgkmcnt(4)
    v_mfma_f32_16x16x32_bf16 v[160:163], v[48:51], v[72:75], v[160:163]
    ds_read_b128 v[40:43], v6 offset:20480
    s_add_u32 m0, s32, 0
    v_mfma_f32_16x16x32_bf16 v[168:171], v[48:51], v[76:79], v[168:171]
    s_add_u32 s33, s6, 131072
    v_mfma_f32_16x16x32_bf16 v[164:167], v[52:55], v[72:75], v[164:167]
    ds_read_b128 v[44:47], v6 offset:22528
    v_mfma_f32_16x16x32_bf16 v[172:175], v[52:55], v[76:79], v[172:175]
    buffer_load_dwordx4 v2, s[20:23], s33 offen nt lds
    s_waitcnt lgkmcnt(4)
    v_mfma_f32_16x16x32_bf16 v[176:179], v[56:59], v[72:75], v[176:179]
    ds_read_b128 v[48:51], v6 offset:24576
    v_mfma_f32_16x16x32_bf16 v[184:187], v[56:59], v[76:79], v[184:187]
    v_mfma_f32_16x16x32_bf16 v[180:183], v[60:63], v[72:75], v[180:183]
    ds_read_b128 v[52:55], v6 offset:26624
    s_add_u32 m0, s32, 4096
    v_mfma_f32_16x16x32_bf16 v[188:191], v[60:63], v[76:79], v[188:191]
    s_waitcnt lgkmcnt(4)
    s_add_u32 s33, s6, 147456
    v_mfma_f32_16x16x32_bf16 v[192:195], v[20:23], v[64:67], 0
    ds_read_b128 v[56:59], v6 offset:28672
    v_mfma_f32_16x16x32_bf16 v[200:203], v[20:23], v[68:71], 0
    buffer_load_dwordx4 v2, s[20:23], s33 offen nt lds
    v_mfma_f32_16x16x32_bf16 v[196:199], v[36:39], v[64:67], 0
    ds_read_b128 v[60:63], v6 offset:30720
    v_mfma_f32_16x16x32_bf16 v[204:207], v[36:39], v[68:71], 0
    s_waitcnt lgkmcnt(4)
    v_mfma_f32_16x16x32_bf16 v[208:211], v[40:43], v[64:67], 0
    ds_read_b128 v[20:23], v7 offset:16384
    s_add_u32 m0, s32, 8192
    v_mfma_f32_16x16x32_bf16 v[216:219], v[40:43], v[68:71], 0
    s_add_u32 s33, s6, 163840
    v_mfma_f32_16x16x32_bf16 v[212:215], v[44:47], v[64:67], 0
    ds_read_b128 v[36:39], v7 offset:18432
    v_mfma_f32_16x16x32_bf16 v[220:223], v[44:47], v[68:71], 0
    buffer_load_dwordx4 v2, s[20:23], s33 offen nt lds
    s_waitcnt lgkmcnt(4)
    v_mfma_f32_16x16x32_bf16 v[224:227], v[48:51], v[64:67], 0
    ds_read_b128 v[40:43], v7 offset:20480
    v_mfma_f32_16x16x32_bf16 v[232:235], v[48:51], v[68:71], 0
    v_mfma_f32_16x16x32_bf16 v[228:231], v[52:55], v[64:67], 0
    ds_read_b128 v[44:47], v7 offset:22528
    s_add_u32 m0, s32, 12288
    v_mfma_f32_16x16x32_bf16 v[236:239], v[52:55], v[68:71], 0
    s_waitcnt lgkmcnt(4)
    s_add_u32 s33, s6, 180224
    v_mfma_f32_16x16x32_bf16 v[240:243], v[56:59], v[64:67], 0
    ds_read_b128 v[48:51], v7 offset:24576
    v_mfma_f32_16x16x32_bf16 v[248:251], v[56:59], v[68:71], 0
    buffer_load_dwordx4 v2, s[20:23], s33 offen nt lds
    v_mfma_f32_16x16x32_bf16 v[244:247], v[60:63], v[64:67], 0
    ds_read_b128 v[52:55], v7 offset:26624
    v_mfma_f32_16x16x32_bf16 v[252:255], v[60:63], v[68:71], 0
    s_waitcnt lgkmcnt(4)
    v_mfma_f32_16x16x32_bf16 v[192:195], v[20:23], v[72:75], v[192:195]
    ds_read_b128 v[56:59], v7 offset:28672
    s_add_u32 m0, s32, 16384
    v_mfma_f32_16x16x32_bf16 v[200:203], v[20:23], v[76:79], v[200:203]
    s_add_u32 s33, s6, 196608
    v_mfma_f32_16x16x32_bf16 v[196:199], v[36:39], v[72:75], v[196:199]
    ds_read_b128 v[60:63], v7 offset:30720
    v_mfma_f32_16x16x32_bf16 v[204:207], v[36:39], v[76:79], v[204:207]
    buffer_load_dwordx4 v2, s[20:23], s33 offen nt lds
    s_waitcnt lgkmcnt(4)
    v_mfma_f32_16x16x32_bf16 v[208:211], v[40:43], v[72:75], v[208:211]
    v_mfma_f32_16x16x32_bf16 v[216:219], v[40:43], v[76:79], v[216:219]
    s_add_u32 m0, s32, 20480
    s_add_u32 s33, s6, 212992
    buffer_load_dwordx4 v2, s[20:23], s33 offen nt lds
    s_add_u32 m0, s32, 24576
    s_add_u32 s33, s6, 229376
    buffer_load_dwordx4 v2, s[20:23], s33 offen nt lds
    s_add_u32 m0, s32, 28672
    s_add_u32 s33, s6, 245760
    buffer_load_dwordx4 v2, s[20:23], s33 offen nt lds
    s_waitcnt vmcnt(12)
    s_waitcnt vmcnt(8)
    s_barrier
    ds_read_b128 v[20:23], v6 offset:32768
    v_mfma_f32_16x16x32_bf16 v[212:215], v[44:47], v[72:75], v[212:215]
    ds_read_b128 v[36:39], v6 offset:34816
    s_add_u32 m0, s32, 32768
    v_mfma_f32_16x16x32_bf16 v[220:223], v[44:47], v[76:79], v[220:223]
    s_waitcnt lgkmcnt(4)
    s_add_u32 s33, s7, 131072
    v_mfma_f32_16x16x32_bf16 v[224:227], v[48:51], v[72:75], v[224:227]
    ds_read_b128 v[40:43], v6 offset:36864
    v_mfma_f32_16x16x32_bf16 v[232:235], v[48:51], v[76:79], v[232:235]
    buffer_load_dwordx4 v2, s[20:23], s33 offen nt lds
    v_mfma_f32_16x16x32_bf16 v[228:231], v[52:55], v[72:75], v[228:231]
    ds_read_b128 v[44:47], v6 offset:38912
    v_mfma_f32_16x16x32_bf16 v[236:239], v[52:55], v[76:79], v[236:239]
    s_waitcnt lgkmcnt(4)
    v_mfma_f32_16x16x32_bf16 v[240:243], v[56:59], v[72:75], v[240:243]
    ds_read_b128 v[48:51], v6 offset:40960
    s_add_u32 m0, s32, 36864
    v_mfma_f32_16x16x32_bf16 v[248:251], v[56:59], v[76:79], v[248:251]
    s_add_u32 s33, s7, 147456
    v_mfma_f32_16x16x32_bf16 v[244:247], v[60:63], v[72:75], v[244:247]
    ds_read_b128 v[52:55], v6 offset:43008
    v_mfma_f32_16x16x32_bf16 v[252:255], v[60:63], v[76:79], v[252:255]
    buffer_load_dwordx4 v2, s[20:23], s33 offen nt lds
    s_waitcnt lgkmcnt(4)
    v_mfma_f32_16x16x32_bf16 v[128:131], v[20:23], v[80:83], v[128:131]
    ds_read_b128 v[56:59], v6 offset:45056
    v_mfma_f32_16x16x32_bf16 v[136:139], v[20:23], v[84:87], v[136:139]
    v_mfma_f32_16x16x32_bf16 v[132:135], v[36:39], v[80:83], v[132:135]
    ds_read_b128 v[60:63], v6 offset:47104
    s_add_u32 m0, s32, 40960
    v_mfma_f32_16x16x32_bf16 v[140:143], v[36:39], v[84:87], v[140:143]
    s_waitcnt lgkmcnt(4)
    s_add_u32 s33, s7, 163840
    v_mfma_f32_16x16x32_bf16 v[144:147], v[40:43], v[80:83], v[144:147]
    ds_read_b128 v[20:23], v7 offset:32768
    v_mfma_f32_16x16x32_bf16 v[152:155], v[40:43], v[84:87], v[152:155]
    buffer_load_dwordx4 v2, s[20:23], s33 offen nt lds
    v_mfma_f32_16x16x32_bf16 v[148:151], v[44:47], v[80:83], v[148:151]
    ds_read_b128 v[36:39], v7 offset:34816
    v_mfma_f32_16x16x32_bf16 v[156:159], v[44:47], v[84:87], v[156:159]
    s_waitcnt lgkmcnt(4)
    v_mfma_f32_16x16x32_bf16 v[160:163], v[48:51], v[80:83], v[160:163]
    ds_read_b128 v[40:43], v7 offset:36864
    s_add_u32 m0, s32, 45056
    v_mfma_f32_16x16x32_bf16 v[168:171], v[48:51], v[84:87], v[168:171]
    s_add_u32 s33, s7, 180224
    v_mfma_f32_16x16x32_bf16 v[164:167], v[52:55], v[80:83], v[164:167]
    ds_read_b128 v[44:47], v7 offset:38912
    v_mfma_f32_16x16x32_bf16 v[172:175], v[52:55], v[84:87], v[172:175]
    buffer_load_dwordx4 v2, s[20:23], s33 offen nt lds
    s_waitcnt lgkmcnt(4)
    v_mfma_f32_16x16x32_bf16 v[176:179], v[56:59], v[80:83], v[176:179]
    ds_read_b128 v[48:51], v7 offset:40960
    v_mfma_f32_16x16x32_bf16 v[184:187], v[56:59], v[84:87], v[184:187]
    v_mfma_f32_16x16x32_bf16 v[180:183], v[60:63], v[80:83], v[180:183]
    ds_read_b128 v[52:55], v7 offset:43008
    s_add_u32 m0, s32, 49152
    v_mfma_f32_16x16x32_bf16 v[188:191], v[60:63], v[84:87], v[188:191]
    s_waitcnt lgkmcnt(4)
    s_add_u32 s33, s7, 196608
    v_mfma_f32_16x16x32_bf16 v[128:131], v[20:23], v[88:91], v[128:131]
    ds_read_b128 v[56:59], v7 offset:45056
    v_mfma_f32_16x16x32_bf16 v[136:139], v[20:23], v[92:95], v[136:139]
    buffer_load_dwordx4 v2, s[20:23], s33 offen nt lds
    v_mfma_f32_16x16x32_bf16 v[132:135], v[36:39], v[88:91], v[132:135]
    ds_read_b128 v[60:63], v7 offset:47104
    v_mfma_f32_16x16x32_bf16 v[140:143], v[36:39], v[92:95], v[140:143]
    s_waitcnt lgkmcnt(4)
    v_mfma_f32_16x16x32_bf16 v[144:147], v[40:43], v[88:91], v[144:147]
    ds_read_b128 v[20:23], v6 offset:49152
    s_add_u32 m0, s32, 53248
    v_mfma_f32_16x16x32_bf16 v[152:155], v[40:43], v[92:95], v[152:155]
    s_add_u32 s33, s7, 212992
    v_mfma_f32_16x16x32_bf16 v[148:151], v[44:47], v[88:91], v[148:151]
    ds_read_b128 v[36:39], v6 offset:51200
    v_mfma_f32_16x16x32_bf16 v[156:159], v[44:47], v[92:95], v[156:159]
    buffer_load_dwordx4 v2, s[20:23], s33 offen nt lds
    s_waitcnt lgkmcnt(4)
    v_mfma_f32_16x16x32_bf16 v[160:163], v[48:51], v[88:91], v[160:163]
    ds_read_b128 v[40:43], v6 offset:53248
    v_mfma_f32_16x16x32_bf16 v[168:171], v[48:51], v[92:95], v[168:171]
    v_mfma_f32_16x16x32_bf16 v[164:167], v[52:55], v[88:91], v[164:167]
    ds_read_b128 v[44:47], v6 offset:55296
    s_add_u32 m0, s32, 57344
    v_mfma_f32_16x16x32_bf16 v[172:175], v[52:55], v[92:95], v[172:175]
    s_waitcnt lgkmcnt(4)
    s_add_u32 s33, s7, 229376
    v_mfma_f32_16x16x32_bf16 v[176:179], v[56:59], v[88:91], v[176:179]
    ds_read_b128 v[48:51], v6 offset:57344
    v_mfma_f32_16x16x32_bf16 v[184:187], v[56:59], v[92:95], v[184:187]
    buffer_load_dwordx4 v2, s[20:23], s33 offen nt lds
    v_mfma_f32_16x16x32_bf16 v[180:183], v[60:63], v[88:91], v[180:183]
    ds_read_b128 v[52:55], v6 offset:59392
    v_mfma_f32_16x16x32_bf16 v[188:191], v[60:63], v[92:95], v[188:191]
    s_waitcnt lgkmcnt(4)
    v_mfma_f32_16x16x32_bf16 v[192:195], v[20:23], v[80:83], v[192:195]
    ds_read_b128 v[56:59], v6 offset:61440
    s_add_u32 m0, s32, 61440
    v_mfma_f32_16x16x32_bf16 v[200:203], v[20:23], v[84:87], v[200:203]
    s_add_u32 s33, s7, 245760
    v_mfma_f32_16x16x32_bf16 v[196:199], v[36:39], v[80:83], v[196:199]
    ds_read_b128 v[60:63], v6 offset:63488
    v_mfma_f32_16x16x32_bf16 v[204:207], v[36:39], v[84:87], v[204:207]
    buffer_load_dwordx4 v2, s[20:23], s33 offen nt lds
    s_waitcnt lgkmcnt(4)
    v_mfma_f32_16x16x32_bf16 v[208:211], v[40:43], v[80:83], v[208:211]
    ds_read_b128 v[20:23], v7 offset:49152
    v_mfma_f32_16x16x32_bf16 v[216:219], v[40:43], v[84:87], v[216:219]
    v_mfma_f32_16x16x32_bf16 v[212:215], v[44:47], v[80:83], v[212:215]
    ds_read_b128 v[36:39], v7 offset:51200
    v_mfma_f32_16x16x32_bf16 v[220:223], v[44:47], v[84:87], v[220:223]
    s_waitcnt lgkmcnt(4)
    v_mfma_f32_16x16x32_bf16 v[224:227], v[48:51], v[80:83], v[224:227]
    ds_read_b128 v[40:43], v7 offset:53248
    v_mfma_f32_16x16x32_bf16 v[232:235], v[48:51], v[84:87], v[232:235]
    v_mfma_f32_16x16x32_bf16 v[228:231], v[52:55], v[80:83], v[228:231]
    ds_read_b128 v[44:47], v7 offset:55296
    v_mfma_f32_16x16x32_bf16 v[236:239], v[52:55], v[84:87], v[236:239]
    s_waitcnt lgkmcnt(4)
    v_mfma_f32_16x16x32_bf16 v[240:243], v[56:59], v[80:83], v[240:243]
    ds_read_b128 v[48:51], v7 offset:57344
    v_mfma_f32_16x16x32_bf16 v[248:251], v[56:59], v[84:87], v[248:251]
    v_mfma_f32_16x16x32_bf16 v[244:247], v[60:63], v[80:83], v[244:247]
    ds_read_b128 v[52:55], v7 offset:59392
    v_mfma_f32_16x16x32_bf16 v[252:255], v[60:63], v[84:87], v[252:255]
    s_waitcnt lgkmcnt(4)
    v_mfma_f32_16x16x32_bf16 v[192:195], v[20:23], v[88:91], v[192:195]
    ds_read_b128 v[56:59], v7 offset:61440
    v_mfma_f32_16x16x32_bf16 v[200:203], v[20:23], v[92:95], v[200:203]
    v_mfma_f32_16x16x32_bf16 v[196:199], v[36:39], v[88:91], v[196:199]
    ds_read_b128 v[60:63], v7 offset:63488
    v_mfma_f32_16x16x32_bf16 v[204:207], v[36:39], v[92:95], v[204:207]
    s_waitcnt lgkmcnt(4)
    v_mfma_f32_16x16x32_bf16 v[208:211], v[40:43], v[88:91], v[208:211]
    v_mfma_f32_16x16x32_bf16 v[216:219], v[40:43], v[92:95], v[216:219]
    s_waitcnt vmcnt(12)
    s_waitcnt vmcnt(8)
    s_barrier
    ds_read_b128 v[20:23], v4 offset:0
    v_mfma_f32_16x16x32_bf16 v[212:215], v[44:47], v[88:91], v[212:215]
    ds_read_b128 v[36:39], v4 offset:2048
    s_add_u32 m0, s32, 65536
    v_mfma_f32_16x16x32_bf16 v[220:223], v[44:47], v[92:95], v[220:223]
    s_waitcnt lgkmcnt(4)
    s_add_u32 s33, s4, 0
    v_mfma_f32_16x16x32_bf16 v[224:227], v[48:51], v[88:91], v[224:227]
    ds_read_b128 v[40:43], v4 offset:4096
    v_mfma_f32_16x16x32_bf16 v[232:235], v[48:51], v[92:95], v[232:235]
    buffer_load_dwordx4 v3, s[24:27], s33 offen nt lds
    v_mfma_f32_16x16x32_bf16 v[228:231], v[52:55], v[88:91], v[228:231]
    ds_read_b128 v[44:47], v4 offset:6144
    v_mfma_f32_16x16x32_bf16 v[236:239], v[52:55], v[92:95], v[236:239]
    s_waitcnt lgkmcnt(4)
    v_mfma_f32_16x16x32_bf16 v[240:243], v[56:59], v[88:91], v[240:243]
    ds_read_b128 v[48:51], v4 offset:8192
    s_add_u32 m0, s32, 69632
    v_mfma_f32_16x16x32_bf16 v[248:251], v[56:59], v[92:95], v[248:251]
    s_add_u32 s33, s4, 16384
    v_mfma_f32_16x16x32_bf16 v[244:247], v[60:63], v[88:91], v[244:247]
    ds_read_b128 v[52:55], v4 offset:10240
    v_mfma_f32_16x16x32_bf16 v[252:255], v[60:63], v[92:95], v[252:255]
    buffer_load_dwordx4 v3, s[24:27], s33 offen nt lds
    s_waitcnt lgkmcnt(4)
    v_mfma_f32_16x16x32_bf16 v[128:131], v[20:23], v[96:99], v[128:131]
    ds_read_b128 v[56:59], v4 offset:12288
    v_mfma_f32_16x16x32_bf16 v[136:139], v[20:23], v[100:103], v[136:139]
    v_mfma_f32_16x16x32_bf16 v[132:135], v[36:39], v[96:99], v[132:135]
    ds_read_b128 v[60:63], v4 offset:14336
    s_add_u32 m0, s32, 73728
    v_mfma_f32_16x16x32_bf16 v[140:143], v[36:39], v[100:103], v[140:143]
    s_waitcnt lgkmcnt(4)
    s_add_u32 s33, s4, 32768
    v_mfma_f32_16x16x32_bf16 v[144:147], v[40:43], v[96:99], v[144:147]
    ds_read_b128 v[20:23], v5 offset:0
    v_mfma_f32_16x16x32_bf16 v[152:155], v[40:43], v[100:103], v[152:155]
    buffer_load_dwordx4 v3, s[24:27], s33 offen nt lds
    v_mfma_f32_16x16x32_bf16 v[148:151], v[44:47], v[96:99], v[148:151]
    ds_read_b128 v[36:39], v5 offset:2048
    v_mfma_f32_16x16x32_bf16 v[156:159], v[44:47], v[100:103], v[156:159]
    s_waitcnt lgkmcnt(4)
    v_mfma_f32_16x16x32_bf16 v[160:163], v[48:51], v[96:99], v[160:163]
    ds_read_b128 v[40:43], v5 offset:4096
    s_add_u32 m0, s32, 77824
    v_mfma_f32_16x16x32_bf16 v[168:171], v[48:51], v[100:103], v[168:171]
    s_add_u32 s33, s4, 49152
    v_mfma_f32_16x16x32_bf16 v[164:167], v[52:55], v[96:99], v[164:167]
    ds_read_b128 v[44:47], v5 offset:6144
    v_mfma_f32_16x16x32_bf16 v[172:175], v[52:55], v[100:103], v[172:175]
    buffer_load_dwordx4 v3, s[24:27], s33 offen nt lds
    s_waitcnt lgkmcnt(4)
    v_mfma_f32_16x16x32_bf16 v[176:179], v[56:59], v[96:99], v[176:179]
    ds_read_b128 v[48:51], v5 offset:8192
    v_mfma_f32_16x16x32_bf16 v[184:187], v[56:59], v[100:103], v[184:187]
    v_mfma_f32_16x16x32_bf16 v[180:183], v[60:63], v[96:99], v[180:183]
    ds_read_b128 v[52:55], v5 offset:10240
    s_add_u32 m0, s32, 81920
    v_mfma_f32_16x16x32_bf16 v[188:191], v[60:63], v[100:103], v[188:191]
    s_waitcnt lgkmcnt(4)
    s_add_u32 s33, s5, 0
    v_mfma_f32_16x16x32_bf16 v[128:131], v[20:23], v[104:107], v[128:131]
    ds_read_b128 v[56:59], v5 offset:12288
    v_mfma_f32_16x16x32_bf16 v[136:139], v[20:23], v[108:111], v[136:139]
    buffer_load_dwordx4 v3, s[24:27], s33 offen nt lds
    v_mfma_f32_16x16x32_bf16 v[132:135], v[36:39], v[104:107], v[132:135]
    ds_read_b128 v[60:63], v5 offset:14336
    v_mfma_f32_16x16x32_bf16 v[140:143], v[36:39], v[108:111], v[140:143]
    s_waitcnt lgkmcnt(4)
    v_mfma_f32_16x16x32_bf16 v[144:147], v[40:43], v[104:107], v[144:147]
    ds_read_b128 v[20:23], v4 offset:16384
    s_add_u32 m0, s32, 86016
    v_mfma_f32_16x16x32_bf16 v[152:155], v[40:43], v[108:111], v[152:155]
    s_add_u32 s33, s5, 16384
    v_mfma_f32_16x16x32_bf16 v[148:151], v[44:47], v[104:107], v[148:151]
    ds_read_b128 v[36:39], v4 offset:18432
    v_mfma_f32_16x16x32_bf16 v[156:159], v[44:47], v[108:111], v[156:159]
    buffer_load_dwordx4 v3, s[24:27], s33 offen nt lds
    s_waitcnt lgkmcnt(4)
    v_mfma_f32_16x16x32_bf16 v[160:163], v[48:51], v[104:107], v[160:163]
    ds_read_b128 v[40:43], v4 offset:20480
    v_mfma_f32_16x16x32_bf16 v[168:171], v[48:51], v[108:111], v[168:171]
    v_mfma_f32_16x16x32_bf16 v[164:167], v[52:55], v[104:107], v[164:167]
    ds_read_b128 v[44:47], v4 offset:22528
    s_add_u32 m0, s32, 90112
    v_mfma_f32_16x16x32_bf16 v[172:175], v[52:55], v[108:111], v[172:175]
    s_waitcnt lgkmcnt(4)
    s_add_u32 s33, s5, 32768
    v_mfma_f32_16x16x32_bf16 v[176:179], v[56:59], v[104:107], v[176:179]
    ds_read_b128 v[48:51], v4 offset:24576
    v_mfma_f32_16x16x32_bf16 v[184:187], v[56:59], v[108:111], v[184:187]
    buffer_load_dwordx4 v3, s[24:27], s33 offen nt lds
    v_mfma_f32_16x16x32_bf16 v[180:183], v[60:63], v[104:107], v[180:183]
    ds_read_b128 v[52:55], v4 offset:26624
    v_mfma_f32_16x16x32_bf16 v[188:191], v[60:63], v[108:111], v[188:191]
    s_waitcnt lgkmcnt(4)
    v_mfma_f32_16x16x32_bf16 v[192:195], v[20:23], v[96:99], v[192:195]
    ds_read_b128 v[56:59], v4 offset:28672
    s_add_u32 m0, s32, 94208
    v_mfma_f32_16x16x32_bf16 v[200:203], v[20:23], v[100:103], v[200:203]
    s_add_u32 s33, s5, 49152
    v_mfma_f32_16x16x32_bf16 v[196:199], v[36:39], v[96:99], v[196:199]
    ds_read_b128 v[60:63], v4 offset:30720
    v_mfma_f32_16x16x32_bf16 v[204:207], v[36:39], v[100:103], v[204:207]
    buffer_load_dwordx4 v3, s[24:27], s33 offen nt lds
    s_waitcnt lgkmcnt(4)
    v_mfma_f32_16x16x32_bf16 v[208:211], v[40:43], v[96:99], v[208:211]
    ds_read_b128 v[20:23], v5 offset:16384
    v_mfma_f32_16x16x32_bf16 v[216:219], v[40:43], v[100:103], v[216:219]
    v_mfma_f32_16x16x32_bf16 v[212:215], v[44:47], v[96:99], v[212:215]
    ds_read_b128 v[36:39], v5 offset:18432
    v_mfma_f32_16x16x32_bf16 v[220:223], v[44:47], v[100:103], v[220:223]
    s_waitcnt lgkmcnt(4)
    v_mfma_f32_16x16x32_bf16 v[224:227], v[48:51], v[96:99], v[224:227]
    ds_read_b128 v[40:43], v5 offset:20480
    v_mfma_f32_16x16x32_bf16 v[232:235], v[48:51], v[100:103], v[232:235]
    v_mfma_f32_16x16x32_bf16 v[228:231], v[52:55], v[96:99], v[228:231]
    ds_read_b128 v[44:47], v5 offset:22528
    v_mfma_f32_16x16x32_bf16 v[236:239], v[52:55], v[100:103], v[236:239]
    s_waitcnt lgkmcnt(4)
    v_mfma_f32_16x16x32_bf16 v[240:243], v[56:59], v[96:99], v[240:243]
    ds_read_b128 v[48:51], v5 offset:24576
    v_mfma_f32_16x16x32_bf16 v[248:251], v[56:59], v[100:103], v[248:251]
    v_mfma_f32_16x16x32_bf16 v[244:247], v[60:63], v[96:99], v[244:247]
    ds_read_b128 v[52:55], v5 offset:26624
    v_mfma_f32_16x16x32_bf16 v[252:255], v[60:63], v[100:103], v[252:255]
    s_waitcnt lgkmcnt(4)
    v_mfma_f32_16x16x32_bf16 v[192:195], v[20:23], v[104:107], v[192:195]
    ds_read_b128 v[56:59], v5 offset:28672
    v_mfma_f32_16x16x32_bf16 v[200:203], v[20:23], v[108:111], v[200:203]
    v_mfma_f32_16x16x32_bf16 v[196:199], v[36:39], v[104:107], v[196:199]
    ds_read_b128 v[60:63], v5 offset:30720
    v_mfma_f32_16x16x32_bf16 v[204:207], v[36:39], v[108:111], v[204:207]
    s_waitcnt lgkmcnt(4)
    v_mfma_f32_16x16x32_bf16 v[208:211], v[40:43], v[104:107], v[208:211]
    v_mfma_f32_16x16x32_bf16 v[216:219], v[40:43], v[108:111], v[216:219]
    s_waitcnt vmcnt(12)
    s_waitcnt vmcnt(8)
    s_barrier
    ds_read_b128 v[20:23], v4 offset:32768
    v_mfma_f32_16x16x32_bf16 v[212:215], v[44:47], v[104:107], v[212:215]
    ds_read_b128 v[36:39], v4 offset:34816
    s_add_u32 m0, s32, 98304
    v_mfma_f32_16x16x32_bf16 v[220:223], v[44:47], v[108:111], v[220:223]
    s_waitcnt lgkmcnt(4)
    s_add_u32 s33, s6, 0
    v_mfma_f32_16x16x32_bf16 v[224:227], v[48:51], v[104:107], v[224:227]
    ds_read_b128 v[40:43], v4 offset:36864
    v_mfma_f32_16x16x32_bf16 v[232:235], v[48:51], v[108:111], v[232:235]
    buffer_load_dwordx4 v3, s[24:27], s33 offen nt lds
    v_mfma_f32_16x16x32_bf16 v[228:231], v[52:55], v[104:107], v[228:231]
    ds_read_b128 v[44:47], v4 offset:38912
    v_mfma_f32_16x16x32_bf16 v[236:239], v[52:55], v[108:111], v[236:239]
    s_waitcnt lgkmcnt(4)
    v_mfma_f32_16x16x32_bf16 v[240:243], v[56:59], v[104:107], v[240:243]
    ds_read_b128 v[48:51], v4 offset:40960
    s_add_u32 m0, s32, 102400
    v_mfma_f32_16x16x32_bf16 v[248:251], v[56:59], v[108:111], v[248:251]
    s_add_u32 s33, s6, 16384
    v_mfma_f32_16x16x32_bf16 v[244:247], v[60:63], v[104:107], v[244:247]
    ds_read_b128 v[52:55], v4 offset:43008
    v_mfma_f32_16x16x32_bf16 v[252:255], v[60:63], v[108:111], v[252:255]
    buffer_load_dwordx4 v3, s[24:27], s33 offen nt lds
    s_waitcnt lgkmcnt(4)
    v_mfma_f32_16x16x32_bf16 v[128:131], v[20:23], v[112:115], v[128:131]
    ds_read_b128 v[56:59], v4 offset:45056
    v_mfma_f32_16x16x32_bf16 v[136:139], v[20:23], v[116:119], v[136:139]
    v_mfma_f32_16x16x32_bf16 v[132:135], v[36:39], v[112:115], v[132:135]
    ds_read_b128 v[60:63], v4 offset:47104
    s_add_u32 m0, s32, 106496
    v_mfma_f32_16x16x32_bf16 v[140:143], v[36:39], v[116:119], v[140:143]
    s_waitcnt lgkmcnt(4)
    s_add_u32 s33, s6, 32768
    v_mfma_f32_16x16x32_bf16 v[144:147], v[40:43], v[112:115], v[144:147]
    ds_read_b128 v[20:23], v5 offset:32768
    v_mfma_f32_16x16x32_bf16 v[152:155], v[40:43], v[116:119], v[152:155]
    buffer_load_dwordx4 v3, s[24:27], s33 offen nt lds
    v_mfma_f32_16x16x32_bf16 v[148:151], v[44:47], v[112:115], v[148:151]
    ds_read_b128 v[36:39], v5 offset:34816
    v_mfma_f32_16x16x32_bf16 v[156:159], v[44:47], v[116:119], v[156:159]
    s_waitcnt lgkmcnt(4)
    v_mfma_f32_16x16x32_bf16 v[160:163], v[48:51], v[112:115], v[160:163]
    ds_read_b128 v[40:43], v5 offset:36864
    s_add_u32 m0, s32, 110592
    v_mfma_f32_16x16x32_bf16 v[168:171], v[48:51], v[116:119], v[168:171]
    s_add_u32 s33, s6, 49152
    v_mfma_f32_16x16x32_bf16 v[164:167], v[52:55], v[112:115], v[164:167]
    ds_read_b128 v[44:47], v5 offset:38912
    v_mfma_f32_16x16x32_bf16 v[172:175], v[52:55], v[116:119], v[172:175]
    buffer_load_dwordx4 v3, s[24:27], s33 offen nt lds
    s_waitcnt lgkmcnt(4)
    v_mfma_f32_16x16x32_bf16 v[176:179], v[56:59], v[112:115], v[176:179]
    ds_read_b128 v[48:51], v5 offset:40960
    v_mfma_f32_16x16x32_bf16 v[184:187], v[56:59], v[116:119], v[184:187]
    v_mfma_f32_16x16x32_bf16 v[180:183], v[60:63], v[112:115], v[180:183]
    ds_read_b128 v[52:55], v5 offset:43008
    s_add_u32 m0, s32, 114688
    v_mfma_f32_16x16x32_bf16 v[188:191], v[60:63], v[116:119], v[188:191]
    s_waitcnt lgkmcnt(4)
    s_add_u32 s33, s7, 0
    v_mfma_f32_16x16x32_bf16 v[128:131], v[20:23], v[120:123], v[128:131]
    ds_read_b128 v[56:59], v5 offset:45056
    v_mfma_f32_16x16x32_bf16 v[136:139], v[20:23], v[124:127], v[136:139]
    buffer_load_dwordx4 v3, s[24:27], s33 offen nt lds
    v_mfma_f32_16x16x32_bf16 v[132:135], v[36:39], v[120:123], v[132:135]
    ds_read_b128 v[60:63], v5 offset:47104
    v_mfma_f32_16x16x32_bf16 v[140:143], v[36:39], v[124:127], v[140:143]
    s_waitcnt lgkmcnt(4)
    v_mfma_f32_16x16x32_bf16 v[144:147], v[40:43], v[120:123], v[144:147]
    ds_read_b128 v[20:23], v4 offset:49152
    s_add_u32 m0, s32, 118784
    v_mfma_f32_16x16x32_bf16 v[152:155], v[40:43], v[124:127], v[152:155]
    s_add_u32 s33, s7, 16384
    v_mfma_f32_16x16x32_bf16 v[148:151], v[44:47], v[120:123], v[148:151]
    ds_read_b128 v[36:39], v4 offset:51200
    v_mfma_f32_16x16x32_bf16 v[156:159], v[44:47], v[124:127], v[156:159]
    buffer_load_dwordx4 v3, s[24:27], s33 offen nt lds
    s_waitcnt lgkmcnt(4)
    v_mfma_f32_16x16x32_bf16 v[160:163], v[48:51], v[120:123], v[160:163]
    ds_read_b128 v[40:43], v4 offset:53248
    v_mfma_f32_16x16x32_bf16 v[168:171], v[48:51], v[124:127], v[168:171]
    v_mfma_f32_16x16x32_bf16 v[164:167], v[52:55], v[120:123], v[164:167]
    ds_read_b128 v[44:47], v4 offset:55296
    s_add_u32 m0, s32, 122880
    v_mfma_f32_16x16x32_bf16 v[172:175], v[52:55], v[124:127], v[172:175]
    s_waitcnt lgkmcnt(4)
    s_add_u32 s33, s7, 32768
    v_mfma_f32_16x16x32_bf16 v[176:179], v[56:59], v[120:123], v[176:179]
    ds_read_b128 v[48:51], v4 offset:57344
    v_mfma_f32_16x16x32_bf16 v[184:187], v[56:59], v[124:127], v[184:187]
    buffer_load_dwordx4 v3, s[24:27], s33 offen nt lds
    v_mfma_f32_16x16x32_bf16 v[180:183], v[60:63], v[120:123], v[180:183]
    ds_read_b128 v[52:55], v4 offset:59392
    v_mfma_f32_16x16x32_bf16 v[188:191], v[60:63], v[124:127], v[188:191]
    s_waitcnt lgkmcnt(4)
    v_mfma_f32_16x16x32_bf16 v[192:195], v[20:23], v[112:115], v[192:195]
    ds_read_b128 v[56:59], v4 offset:61440
    s_add_u32 m0, s32, 126976
    v_mfma_f32_16x16x32_bf16 v[200:203], v[20:23], v[116:119], v[200:203]
    s_add_u32 s33, s7, 49152
    v_mfma_f32_16x16x32_bf16 v[196:199], v[36:39], v[112:115], v[196:199]
    ds_read_b128 v[60:63], v4 offset:63488
    v_mfma_f32_16x16x32_bf16 v[204:207], v[36:39], v[116:119], v[204:207]
    buffer_load_dwordx4 v3, s[24:27], s33 offen nt lds
    s_waitcnt lgkmcnt(4)
    v_mfma_f32_16x16x32_bf16 v[208:211], v[40:43], v[112:115], v[208:211]
    ds_read_b128 v[20:23], v5 offset:49152
    v_mfma_f32_16x16x32_bf16 v[216:219], v[40:43], v[116:119], v[216:219]
    v_mfma_f32_16x16x32_bf16 v[212:215], v[44:47], v[112:115], v[212:215]
    ds_read_b128 v[36:39], v5 offset:51200
    v_mfma_f32_16x16x32_bf16 v[220:223], v[44:47], v[116:119], v[220:223]
    s_waitcnt lgkmcnt(4)
    v_mfma_f32_16x16x32_bf16 v[224:227], v[48:51], v[112:115], v[224:227]
    ds_read_b128 v[40:43], v5 offset:53248
    v_mfma_f32_16x16x32_bf16 v[232:235], v[48:51], v[116:119], v[232:235]
    v_mfma_f32_16x16x32_bf16 v[228:231], v[52:55], v[112:115], v[228:231]
    ds_read_b128 v[44:47], v5 offset:55296
    v_mfma_f32_16x16x32_bf16 v[236:239], v[52:55], v[116:119], v[236:239]
    s_waitcnt lgkmcnt(4)
    v_mfma_f32_16x16x32_bf16 v[240:243], v[56:59], v[112:115], v[240:243]
    ds_read_b128 v[48:51], v5 offset:57344
    v_mfma_f32_16x16x32_bf16 v[248:251], v[56:59], v[116:119], v[248:251]
    v_mfma_f32_16x16x32_bf16 v[244:247], v[60:63], v[112:115], v[244:247]
    ds_read_b128 v[52:55], v5 offset:59392
    v_mfma_f32_16x16x32_bf16 v[252:255], v[60:63], v[116:119], v[252:255]
    s_waitcnt lgkmcnt(4)
    v_mfma_f32_16x16x32_bf16 v[192:195], v[20:23], v[120:123], v[192:195]
    ds_read_b128 v[56:59], v5 offset:61440
    v_mfma_f32_16x16x32_bf16 v[200:203], v[20:23], v[124:127], v[200:203]
    v_mfma_f32_16x16x32_bf16 v[196:199], v[36:39], v[120:123], v[196:199]
    ds_read_b128 v[60:63], v5 offset:63488
    v_mfma_f32_16x16x32_bf16 v[204:207], v[36:39], v[124:127], v[204:207]
    s_waitcnt lgkmcnt(4)
    v_mfma_f32_16x16x32_bf16 v[208:211], v[40:43], v[120:123], v[208:211]
    v_mfma_f32_16x16x32_bf16 v[216:219], v[40:43], v[124:127], v[216:219]
    s_waitcnt vmcnt(12)
    s_barrier
    v_mfma_f32_16x16x32_bf16 v[212:215], v[44:47], v[120:123], v[212:215]
    v_mfma_f32_16x16x32_bf16 v[220:223], v[44:47], v[124:127], v[220:223]
    s_waitcnt lgkmcnt(2)
    v_mfma_f32_16x16x32_bf16 v[224:227], v[48:51], v[120:123], v[224:227]
    v_mfma_f32_16x16x32_bf16 v[232:235], v[48:51], v[124:127], v[232:235]
    v_mfma_f32_16x16x32_bf16 v[228:231], v[52:55], v[120:123], v[228:231]
    v_mfma_f32_16x16x32_bf16 v[236:239], v[52:55], v[124:127], v[236:239]
    s_waitcnt lgkmcnt(1)
    v_mfma_f32_16x16x32_bf16 v[240:243], v[56:59], v[120:123], v[240:243]
    v_mfma_f32_16x16x32_bf16 v[248:251], v[56:59], v[124:127], v[248:251]
    s_waitcnt lgkmcnt(0)
    v_mfma_f32_16x16x32_bf16 v[244:247], v[60:63], v[120:123], v[244:247]
    v_mfma_f32_16x16x32_bf16 v[252:255], v[60:63], v[124:127], v[252:255]
    s_setprio 0
    ds_read_b32 v52, v25 offset:24576
    s_mov_b32 s44, 0x41800000
    v_max3_f32 v48, v128, v129, v130
    v_max3_f32 v49, v136, v137, v138
    v_max3_f32 v48, v48, v131, v132
    v_max3_f32 v49, v49, v139, v140
    v_max3_f32 v48, v48, v133, v134
    v_max3_f32 v49, v49, v141, v142
    v_max3_f32 v48, v48, v135, v144
    v_max3_f32 v49, v49, v143, v152
    v_max3_f32 v48, v48, v145, v146
    v_max3_f32 v49, v49, v153, v154
    v_max3_f32 v48, v48, v147, v148
    v_max3_f32 v49, v49, v155, v156
    v_max3_f32 v48, v48, v149, v150
    v_max3_f32 v49, v49, v157, v158
    v_max3_f32 v48, v48, v151, v160
    v_max3_f32 v49, v49, v159, v168
    v_max3_f32 v48, v48, v161, v162
    v_max3_f32 v49, v49, v169, v170
    v_max3_f32 v48, v48, v163, v164
    v_max3_f32 v49, v49, v171, v172
    v_max3_f32 v48, v48, v165, v166
    v_max3_f32 v49, v49, v173, v174
    v_max3_f32 v48, v48, v167, v176
    v_max3_f32 v49, v49, v175, v184
    v_max3_f32 v48, v48, v177, v178
    v_max3_f32 v49, v49, v185, v186
    v_max3_f32 v48, v48, v179, v180
    v_max3_f32 v49, v49, v187, v188
    v_max3_f32 v48, v48, v181, v182
    v_max3_f32 v49, v49, v189, v190
    v_max3_f32 v48, v48, v183, v192
    v_max3_f32 v49, v49, v191, v200
    v_max3_f32 v48, v48, v193, v194
    v_max3_f32 v49, v49, v201, v202
    v_max3_f32 v48, v48, v195, v196
    v_max3_f32 v49, v49, v203, v204
    v_max3_f32 v48, v48, v197, v198
    v_max3_f32 v49, v49, v205, v206
    v_max3_f32 v48, v48, v199, v208
    v_max3_f32 v49, v49, v207, v216
    v_max3_f32 v48, v48, v209, v210
    v_max3_f32 v49, v49, v217, v218
    v_max3_f32 v48, v48, v211, v212
    v_max3_f32 v49, v49, v219, v220
    v_max3_f32 v48, v48, v213, v214
    v_max3_f32 v49, v49, v221, v222
    v_max3_f32 v48, v48, v215, v224
    v_max3_f32 v49, v49, v223, v232
    s_waitcnt lgkmcnt(0)
    s_waitcnt vmcnt(8)
    s_barrier
    v_max3_f32 v48, v48, v225, v226
    v_max3_f32 v49, v49, v233, v234
    v_max3_f32 v48, v48, v227, v228
    v_max3_f32 v49, v49, v235, v236
    v_max3_f32 v48, v48, v229, v230
    v_max3_f32 v49, v49, v237, v238
    v_max3_f32 v48, v48, v231, v240
    v_max3_f32 v49, v49, v239, v248
    v_max3_f32 v48, v48, v241, v242
    v_max3_f32 v49, v49, v249, v250
    v_max3_f32 v48, v48, v243, v244
    v_max3_f32 v49, v49, v251, v252
    v_max3_f32 v48, v48, v245, v246
    v_max3_f32 v49, v49, v253, v254
    v_max_f32 v48, v48, v247
    v_max_f32 v49, v49, v255
    s_nop 1
    v_permlane16_swap_b32 v48, v49
    v_max_f32 v48, v48, v49
    v_mov_b32 v49, v48
    s_nop 1
    v_permlane32_swap_b32 v48, v49
    v_max_f32 v48, v48, v49
    v_mul_f32 v26, s42, v48
    s_waitcnt lgkmcnt(0)
    v_sub_f32 v53, v26, v52
    v_cmp_lt_f32 vcc, s44, v53
    s_nop 1
    v_cndmask_b32 v26, v52, v26, vcc
    ds_write_b32 v25, v26 offset:25600
    v_mov_b32 v34, v26
    v_mov_b32 v35, v26
    s_nop 1
    v_permlane16_swap_b32 v34, v35
    v_fma_f32 v128, v128, s42, -v34
    v_fma_f32 v129, v129, s42, -v34
    v_fma_f32 v130, v130, s42, -v34
    v_fma_f32 v131, v131, s42, -v34
    v_exp_f32 v128, v128
    v_exp_f32 v129, v129
    v_exp_f32 v130, v130
    v_exp_f32 v131, v131
    v_fma_f32 v132, v132, s42, -v34
    v_fma_f32 v133, v133, s42, -v34
    v_fma_f32 v134, v134, s42, -v34
    v_fma_f32 v135, v135, s42, -v34
    v_exp_f32 v132, v132
    v_exp_f32 v133, v133
    v_exp_f32 v134, v134
    v_exp_f32 v135, v135
    v_cvt_pk_bf16_f32 v64, v128, v129
    v_cvt_pk_bf16_f32 v65, v130, v131
    v_fma_f32 v136, v136, s42, -v35
    v_fma_f32 v137, v137, s42, -v35
    v_fma_f32 v138, v138, s42, -v35
    v_fma_f32 v139, v139, s42, -v35
    v_exp_f32 v136, v136
    v_exp_f32 v137, v137
    v_exp_f32 v138, v138
    v_exp_f32 v139, v139
    v_cvt_pk_bf16_f32 v66, v132, v133
    v_cvt_pk_bf16_f32 v67, v134, v135
    v_fma_f32 v140, v140, s42, -v35
    v_fma_f32 v141, v141, s42, -v35
    s_waitcnt lgkmcnt(0)
    s_waitcnt vmcnt(4)
    s_barrier
    buffer_load_dword v15, v14, s[24:27], s5 offen
    ds_write_b128 v25, v[64:67] offset:0
    v_fma_f32 v142, v142, s42, -v35
    v_fma_f32 v143, v143, s42, -v35
    v_exp_f32 v140, v140
    v_exp_f32 v141, v141
    v_exp_f32 v142, v142
    v_exp_f32 v143, v143
    v_cvt_pk_bf16_f32 v68, v136, v137
    v_cvt_pk_bf16_f32 v69, v138, v139
    v_fma_f32 v144, v144, s42, -v34
    v_fma_f32 v145, v145, s42, -v34
    v_fma_f32 v146, v146, s42, -v34
    v_fma_f32 v147, v147, s42, -v34
    v_exp_f32 v144, v144
    v_exp_f32 v145, v145
    v_exp_f32 v146, v146
    v_exp_f32 v147, v147
    v_cvt_pk_bf16_f32 v70, v140, v141
    v_cvt_pk_bf16_f32 v71, v142, v143
    v_fma_f32 v148, v148, s42, -v34
    v_fma_f32 v149, v149, s42, -v34
    v_fma_f32 v150, v150, s42, -v34
    v_fma_f32 v151, v151, s42, -v34
    v_exp_f32 v148, v148
    v_exp_f32 v149, v149
    v_exp_f32 v150, v150
    v_exp_f32 v151, v151
    v_cvt_pk_bf16_f32 v72, v144, v145
    v_cvt_pk_bf16_f32 v73, v146, v147
    v_fma_f32 v152, v152, s42, -v35
    v_fma_f32 v153, v153, s42, -v35
    v_fma_f32 v154, v154, s42, -v35
    v_fma_f32 v155, v155, s42, -v35
    v_exp_f32 v152, v152
    v_exp_f32 v153, v153
    v_exp_f32 v154, v154
    v_exp_f32 v155, v155
    v_cvt_pk_bf16_f32 v74, v148, v149
    v_cvt_pk_bf16_f32 v75, v150, v151
    v_fma_f32 v156, v156, s42, -v35
    v_fma_f32 v157, v157, s42, -v35
    v_fma_f32 v158, v158, s42, -v35
    s_waitcnt lgkmcnt(0)
    s_waitcnt vmcnt(1)
    s_barrier
    ds_write_b128 v25, v[68:71] offset:1024
    ds_write_b128 v25, v[72:75] offset:8192
    v_fma_f32 v159, v159, s42, -v35
    v_exp_f32 v156, v156
    v_exp_f32 v157, v157
    v_exp_f32 v158, v158
    v_exp_f32 v159, v159
    v_cvt_pk_bf16_f32 v76, v152, v153
    v_cvt_pk_bf16_f32 v77, v154, v155
    v_fma_f32 v160, v160, s42, -v34
    v_fma_f32 v161, v161, s42, -v34
    v_fma_f32 v162, v162, s42, -v34
    v_fma_f32 v163, v163, s42, -v34
    v_exp_f32 v160, v160
    v_exp_f32 v161, v161
    v_exp_f32 v162, v162
    v_exp_f32 v163, v163
    v_cvt_pk_bf16_f32 v78, v156, v157
    v_cvt_pk_bf16_f32 v79, v158, v159
    v_fma_f32 v164, v164, s42, -v34
    v_fma_f32 v165, v165, s42, -v34
    v_fma_f32 v166, v166, s42, -v34
    v_fma_f32 v167, v167, s42, -v34
    v_exp_f32 v164, v164
    v_exp_f32 v165, v165
    v_exp_f32 v166, v166
    v_exp_f32 v167, v167
    v_cvt_pk_bf16_f32 v80, v160, v161
    v_cvt_pk_bf16_f32 v81, v162, v163
    v_fma_f32 v168, v168, s42, -v35
    v_fma_f32 v169, v169, s42, -v35
    v_fma_f32 v170, v170, s42, -v35
    v_fma_f32 v171, v171, s42, -v35
    v_exp_f32 v168, v168
    v_exp_f32 v169, v169
    v_exp_f32 v170, v170
    v_exp_f32 v171, v171
    v_cvt_pk_bf16_f32 v82, v164, v165
    v_cvt_pk_bf16_f32 v83, v166, v167
    v_fma_f32 v172, v172, s42, -v35
    v_fma_f32 v173, v173, s42, -v35
    v_fma_f32 v174, v174, s42, -v35
    v_fma_f32 v175, v175, s42, -v35
    v_exp_f32 v172, v172
    v_exp_f32 v173, v173
    v_exp_f32 v174, v174
    v_exp_f32 v175, v175
    v_cvt_pk_bf16_f32 v84, v168, v169
    v_cvt_pk_bf16_f32 v85, v170, v171
    v_fma_f32 v176, v176, s42, -v34
    v_fma_f32 v177, v177, s42, -v34
    v_fma_f32 v178, v178, s42, -v34
    s_waitcnt lgkmcnt(0)
    s_barrier
    buffer_load_dword v15, v14, s[24:27], s6 offen
    ds_write_b128 v25, v[76:79] offset:9216
    ds_write_b128 v25, v[80:83] offset:16384
    v_fma_f32 v179, v179, s42, -v34
    v_exp_f32 v176, v176
    v_exp_f32 v177, v177
    v_exp_f32 v178, v178
    v_exp_f32 v179, v179
    v_cvt_pk_bf16_f32 v86, v172, v173
    v_cvt_pk_bf16_f32 v87, v174, v175
    v_fma_f32 v180, v180, s42, -v34
    v_fma_f32 v181, v181, s42, -v34
    v_fma_f32 v182, v182, s42, -v34
    v_fma_f32 v183, v183, s42, -v34
    v_exp_f32 v180, v180
    v_exp_f32 v181, v181
    v_exp_f32 v182, v182
    v_exp_f32 v183, v183
    v_cvt_pk_bf16_f32 v88, v176, v177
    v_cvt_pk_bf16_f32 v89, v178, v179
    v_fma_f32 v184, v184, s42, -v35
    v_fma_f32 v185, v185, s42, -v35
    v_fma_f32 v186, v186, s42, -v35
    v_fma_f32 v187, v187, s42, -v35
    v_exp_f32 v184, v184
    v_exp_f32 v185, v185
    v_exp_f32 v186, v186
    v_exp_f32 v187, v187
    v_cvt_pk_bf16_f32 v90, v180, v181
    v_cvt_pk_bf16_f32 v91, v182, v183
    v_fma_f32 v188, v188, s42, -v35
    v_fma_f32 v189, v189, s42, -v35
    v_fma_f32 v190, v190, s42, -v35
    v_fma_f32 v191, v191, s42, -v35
    v_exp_f32 v188, v188
    v_exp_f32 v189, v189
    v_exp_f32 v190, v190
    v_exp_f32 v191, v191
    v_cvt_pk_bf16_f32 v92, v184, v185
    v_cvt_pk_bf16_f32 v93, v186, v187
    v_fma_f32 v192, v192, s42, -v34
    v_fma_f32 v193, v193, s42, -v34
    v_fma_f32 v194, v194, s42, -v34
    v_fma_f32 v195, v195, s42, -v34
    v_exp_f32 v192, v192
    v_exp_f32 v193, v193
    v_exp_f32 v194, v194
    v_exp_f32 v195, v195
    v_cvt_pk_bf16_f32 v94, v188, v189
    v_cvt_pk_bf16_f32 v95, v190, v191
    v_fma_f32 v196, v196, s42, -v34
    v_fma_f32 v197, v197, s42, -v34
    v_fma_f32 v198, v198, s42, -v34
    s_waitcnt lgkmcnt(0)
    s_barrier
    ds_write_b128 v25, v[84:87] offset:17408
    ds_write_b128 v25, v[88:91] offset:24576
    ds_write_b128 v25, v[92:95] offset:25600
    v_fma_f32 v199, v199, s42, -v34
    v_exp_f32 v196, v196
    v_exp_f32 v197, v197
    v_exp_f32 v198, v198
    v_exp_f32 v199, v199
    v_cvt_pk_bf16_f32 v96, v192, v193
    v_cvt_pk_bf16_f32 v97, v194, v195
    v_fma_f32 v200, v200, s42, -v35
    v_fma_f32 v201, v201, s42, -v35
    v_fma_f32 v202, v202, s42, -v35
    v_fma_f32 v203, v203, s42, -v35
    v_exp_f32 v200, v200
    v_exp_f32 v201, v201
    v_exp_f32 v202, v202
    v_exp_f32 v203, v203
    v_cvt_pk_bf16_f32 v98, v196, v197
    v_cvt_pk_bf16_f32 v99, v198, v199
    v_fma_f32 v204, v204, s42, -v35
    v_fma_f32 v205, v205, s42, -v35
    v_fma_f32 v206, v206, s42, -v35
    v_fma_f32 v207, v207, s42, -v35
    v_exp_f32 v204, v204
    v_exp_f32 v205, v205
    v_exp_f32 v206, v206
    v_exp_f32 v207, v207
    v_cvt_pk_bf16_f32 v100, v200, v201
    v_cvt_pk_bf16_f32 v101, v202, v203
    v_fma_f32 v208, v208, s42, -v34
    v_fma_f32 v209, v209, s42, -v34
    v_fma_f32 v210, v210, s42, -v34
    v_fma_f32 v211, v211, s42, -v34
    v_exp_f32 v208, v208
    v_exp_f32 v209, v209
    v_exp_f32 v210, v210
    v_exp_f32 v211, v211
    v_cvt_pk_bf16_f32 v102, v204, v205
    v_cvt_pk_bf16_f32 v103, v206, v207
    v_fma_f32 v212, v212, s42, -v34
    v_fma_f32 v213, v213, s42, -v34
    v_fma_f32 v214, v214, s42, -v34
    v_fma_f32 v215, v215, s42, -v34
    v_exp_f32 v212, v212
    v_exp_f32 v213, v213
    v_exp_f32 v214, v214
    v_exp_f32 v215, v215
    v_cvt_pk_bf16_f32 v104, v208, v209
    v_cvt_pk_bf16_f32 v105, v210, v211
    v_fma_f32 v216, v216, s42, -v35
    v_fma_f32 v217, v217, s42, -v35
    v_fma_f32 v218, v218, s42, -v35
    s_waitcnt lgkmcnt(0)
    s_barrier
    buffer_load_dword v15, v14, s[24:27], s7 offen
    ds_write_b128 v25, v[96:99] offset:0
    ds_write_b128 v25, v[100:103] offset:1024
    v_fma_f32 v219, v219, s42, -v35
    v_exp_f32 v216, v216
    v_exp_f32 v217, v217
    v_exp_f32 v218, v218
    v_exp_f32 v219, v219
    v_cvt_pk_bf16_f32 v106, v212, v213
    v_cvt_pk_bf16_f32 v107, v214, v215
    v_fma_f32 v220, v220, s42, -v35
    v_fma_f32 v221, v221, s42, -v35
    v_fma_f32 v222, v222, s42, -v35
    v_fma_f32 v223, v223, s42, -v35
    v_exp_f32 v220, v220
    v_exp_f32 v221, v221
    v_exp_f32 v222, v222
    v_exp_f32 v223, v223
    v_cvt_pk_bf16_f32 v108, v216, v217
    v_cvt_pk_bf16_f32 v109, v218, v219
    v_fma_f32 v224, v224, s42, -v34
    v_fma_f32 v225, v225, s42, -v34
    v_fma_f32 v226, v226, s42, -v34
    v_fma_f32 v227, v227, s42, -v34
    v_exp_f32 v224, v224
    v_exp_f32 v225, v225
    v_exp_f32 v226, v226
    v_exp_f32 v227, v227
    v_cvt_pk_bf16_f32 v110, v220, v221
    v_cvt_pk_bf16_f32 v111, v222, v223
    v_fma_f32 v228, v228, s42, -v34
    v_fma_f32 v229, v229, s42, -v34
    v_fma_f32 v230, v230, s42, -v34
    v_fma_f32 v231, v231, s42, -v34
    v_exp_f32 v228, v228
    v_exp_f32 v229, v229
    v_exp_f32 v230, v230
    v_exp_f32 v231, v231
    v_cvt_pk_bf16_f32 v112, v224, v225
    v_cvt_pk_bf16_f32 v113, v226, v227
    v_fma_f32 v232, v232, s42, -v35
    v_fma_f32 v233, v233, s42, -v35
    v_fma_f32 v234, v234, s42, -v35
    v_fma_f32 v235, v235, s42, -v35
    v_exp_f32 v232, v232
    v_exp_f32 v233, v233
    v_exp_f32 v234, v234
    v_exp_f32 v235, v235
    v_cvt_pk_bf16_f32 v114, v228, v229
    v_cvt_pk_bf16_f32 v115, v230, v231
    v_fma_f32 v236, v236, s42, -v35
    v_fma_f32 v237, v237, s42, -v35
    v_fma_f32 v238, v238, s42, -v35
    s_waitcnt lgkmcnt(0)
    s_barrier
    ds_write_b128 v25, v[104:107] offset:8192
    ds_write_b128 v25, v[108:111] offset:9216
    ds_write_b128 v25, v[112:115] offset:16384
    v_fma_f32 v239, v239, s42, -v35
    v_exp_f32 v236, v236
    v_exp_f32 v237, v237
    v_exp_f32 v238, v238
    v_exp_f32 v239, v239
    v_cvt_pk_bf16_f32 v116, v232, v233
    v_cvt_pk_bf16_f32 v117, v234, v235
    v_fma_f32 v240, v240, s42, -v34
    v_fma_f32 v241, v241, s42, -v34
    v_fma_f32 v242, v242, s42, -v34
    v_fma_f32 v243, v243, s42, -v34
    v_exp_f32 v240, v240
    v_exp_f32 v241, v241
    v_exp_f32 v242, v242
    v_exp_f32 v243, v243
    v_cvt_pk_bf16_f32 v118, v236, v237
    v_cvt_pk_bf16_f32 v119, v238, v239
    v_fma_f32 v244, v244, s42, -v34
    v_fma_f32 v245, v245, s42, -v34
    v_fma_f32 v246, v246, s42, -v34
    v_fma_f32 v247, v247, s42, -v34
    v_exp_f32 v244, v244
    v_exp_f32 v245, v245
    v_exp_f32 v246, v246
    v_exp_f32 v247, v247
    v_cvt_pk_bf16_f32 v120, v240, v241
    v_cvt_pk_bf16_f32 v121, v242, v243
    v_fma_f32 v248, v248, s42, -v35
    v_fma_f32 v249, v249, s42, -v35
    v_fma_f32 v250, v250, s42, -v35
    v_fma_f32 v251, v251, s42, -v35
    v_exp_f32 v248, v248
    v_exp_f32 v249, v249
    v_exp_f32 v250, v250
    v_exp_f32 v251, v251
    v_cvt_pk_bf16_f32 v122, v244, v245
    v_cvt_pk_bf16_f32 v123, v246, v247
    v_fma_f32 v252, v252, s42, -v35
    v_fma_f32 v253, v253, s42, -v35
    v_fma_f32 v254, v254, s42, -v35
    v_fma_f32 v255, v255, s42, -v35
    v_exp_f32 v252, v252
    v_exp_f32 v253, v253
    v_exp_f32 v254, v254
    v_exp_f32 v255, v255
    v_cvt_pk_bf16_f32 v124, v248, v249
    v_cvt_pk_bf16_f32 v125, v250, v251
    v_cvt_pk_bf16_f32 v126, v252, v253
    v_cvt_pk_bf16_f32 v127, v254, v255
    s_waitcnt lgkmcnt(0)
    s_barrier
    ds_write_b128 v25, v[116:119] offset:17408
    ds_write_b128 v25, v[120:123] offset:24576
    ds_write_b128 v25, v[124:127] offset:25600
    s_waitcnt lgkmcnt(0)
    s_barrier
    s_add_u32 m0, s32, 16384
    s_add_u32 s33, s6, 196608
    buffer_load_dwordx4 v3, s[24:27], s33 offen nt lds
    s_add_u32 m0, s32, 20480
    s_add_u32 s33, s6, 212992
    buffer_load_dwordx4 v3, s[24:27], s33 offen nt lds
    s_add_u32 m0, s32, 24576
    s_add_u32 s33, s6, 229376
    buffer_load_dwordx4 v3, s[24:27], s33 offen nt lds
    s_add_u32 m0, s32, 28672
    s_add_u32 s33, s6, 245760
    buffer_load_dwordx4 v3, s[24:27], s33 offen nt lds
    s_add_u32 m0, s32, 32768
    s_add_u32 s33, s7, 131072
    buffer_load_dwordx4 v3, s[24:27], s33 offen nt lds
    s_add_u32 m0, s32, 36864
    s_add_u32 s33, s7, 147456
    buffer_load_dwordx4 v3, s[24:27], s33 offen nt lds
    s_add_u32 m0, s32, 40960
    s_add_u32 s33, s7, 163840
    buffer_load_dwordx4 v3, s[24:27], s33 offen nt lds
    s_add_u32 m0, s32, 45056
    s_add_u32 s33, s7, 180224
    buffer_load_dwordx4 v3, s[24:27], s33 offen nt lds
    s_barrier
    s_add_u32 m0, s32, 49152
    s_add_u32 s33, s7, 196608
    buffer_load_dwordx4 v3, s[24:27], s33 offen nt lds
    s_add_u32 m0, s32, 53248
    s_add_u32 s33, s7, 212992
    buffer_load_dwordx4 v3, s[24:27], s33 offen nt lds
    s_add_u32 m0, s32, 57344
    s_add_u32 s33, s7, 229376
    buffer_load_dwordx4 v3, s[24:27], s33 offen nt lds
    s_add_u32 m0, s32, 61440
    s_add_u32 s33, s7, 245760
    buffer_load_dwordx4 v3, s[24:27], s33 offen nt lds
    s_waitcnt vmcnt(8)
    s_barrier
    s_waitcnt vmcnt(4)
    s_waitcnt vmcnt(0)
    s_barrier
    s_branch L_fin
L_A:
    v_bfe_u32 v50, v1, 4, 1
    v_lshrrev_b32 v51, 5, v1
    v_lshl_or_b32 v50, v51, 2, v50
    v_xor_b32 v51, v49, v50
    v_lshl_add_u32 v3, v51, 4, v48
    v_and_b32 v48, 15, v1
    v_lshrrev_b32 v49, 4, v1
    v_lshrrev_b32 v50, 1, v48
    v_lshlrev_b32 v51, 7, v48
    s_lshl_b32 s39, s35, 12
    v_xor_b32 v52, v49, v50
    v_lshl_add_u32 v4, v52, 4, v51
    v_xor_b32 v5, 64, v4
    v_add_u32 v6, 0x10000, v4
    v_add_u32 v8, s39, v4
    v_add_u32 v10, s39, v6
    v_add_u32 v7, 0x10000, v5
    v_add_u32 v9, s39, v5
    v_add_u32 v11, s39, v7
    v_lshrrev_b32 v50, 2, v48
    v_lshl_add_u32 v51, v49, 2, v50
    v_lshlrev_b32 v51, 7, v51
    v_lshrrev_b32 v50, 1, v50
    v_and_b32 v52, 1, v49
    v_lshl_or_b32 v50, v52, 2, v50
    v_and_b32 v52, 2, v1
    v_xor_b32 v50, v50, v52
    v_lshl_add_u32 v51, v50, 4, v51
    v_and_b32 v52, 1, v1
    v_lshl_add_u32 v12, v52, 3, v51
    v_xor_b32 v13, 16, v12
    v_xor_b32 v14, 64, v12
    v_xor_b32 v15, 64, v13
    v_add_u32 v16, 0x10000, v12
    v_add_u32 v17, 0x10000, v13
    v_add_u32 v18, 0x10000, v14
    v_add_u32 v19, 0x10000, v15
    v_lshlrev_b32 v24, 9, v48
    v_lshl_add_u32 v24, v49, 4, v24
    s_lshl_b32 s38, s35, 14
    v_add_u32 v24, s38, v24
    s_add_u32 s8, s4, 8192
    s_add_u32 s9, s5, 8192
    s_add_u32 s10, s6, 8192
    s_add_u32 s11, s7, 8192
    s_lshl_b32 s38, s35, 11
    s_add_u32 s38, s38, 131072
    v_lshlrev_b32 v50, 4, v1
    v_add_u32 v25, s38, v50
    s_mov_b32 s42, 0x3db8aa3b
    s_waitcnt vmcnt(0)
    s_setprio 1
    s_barrier
    ds_read_b128 v[64:67], v8 offset:0
    ds_read_b128 v[68:71], v8 offset:2048
    ds_read_b128 v[20:23], v4 offset:16384
    ds_read_b128 v[36:39], v4 offset:18432
    ds_read_b128 v[40:43], v4 offset:20480
    ds_read_b128 v[44:47], v4 offset:22528
    ds_read_b128 v[48:51], v4 offset:24576
    ds_read_b128 v[52:55], v4 offset:26624
    s_waitcnt lgkmcnt(4)
    v_mfma_f32_16x16x32_bf16 v[128:131], v[20:23], v[64:67], 0
    ds_read_b128 v[56:59], v4 offset:28672
    v_mfma_f32_16x16x32_bf16 v[136:139], v[20:23], v[68:71], 0
    v_mfma_f32_16x16x32_bf16 v[132:135], v[36:39], v[64:67], 0
    ds_read_b128 v[60:63], v4 offset:30720
    v_mfma_f32_16x16x32_bf16 v[140:143], v[36:39], v[68:71], 0
    s_waitcnt lgkmcnt(4)
    v_mfma_f32_16x16x32_bf16 v[144:147], v[40:43], v[64:67], 0
    ds_read_b128 v[72:75], v9 offset:0
    ds_read_b128 v[76:79], v9 offset:2048
    v_mfma_f32_16x16x32_bf16 v[152:155], v[40:43], v[68:71], 0
    ds_read_b128 v[20:23], v5 offset:16384
    v_mfma_f32_16x16x32_bf16 v[148:151], v[44:47], v[64:67], 0
    ds_read_b128 v[36:39], v5 offset:18432
    v_mfma_f32_16x16x32_bf16 v[156:159], v[44:47], v[68:71], 0
    s_waitcnt lgkmcnt(6)
    v_mfma_f32_16x16x32_bf16 v[160:163], v[48:51], v[64:67], 0
    ds_read_b128 v[40:43], v5 offset:20480
    v_mfma_f32_16x16x32_bf16 v[168:171], v[48:51], v[68:71], 0
    v_mfma_f32_16x16x32_bf16 v[164:167], v[52:55], v[64:67], 0
    ds_read_b128 v[44:47], v5 offset:22528
    v_mfma_f32_16x16x32_bf16 v[172:175], v[52:55], v[68:71], 0
    s_waitcnt lgkmcnt(6)
    v_mfma_f32_16x16x32_bf16 v[176:179], v[56:59], v[64:67], 0
    ds_read_b128 v[48:51], v5 offset:24576
    v_mfma_f32_16x16x32_bf16 v[184:187], v[56:59], v[68:71], 0
    v_mfma_f32_16x16x32_bf16 v[180:183], v[60:63], v[64:67], 0
    ds_read_b128 v[52:55], v5 offset:26624
    v_mfma_f32_16x16x32_bf16 v[188:191], v[60:63], v[68:71], 0
    s_waitcnt lgkmcnt(4)
    v_mfma_f32_16x16x32_bf16 v[128:131], v[20:23], v[72:75], v[128:131]
    ds_read_b128 v[56:59], v5 offset:28672
    v_mfma_f32_16x16x32_bf16 v[136:139], v[20:23], v[76:79], v[136:139]
    v_mfma_f32_16x16x32_bf16 v[132:135], v[36:39], v[72:75], v[132:135]
    ds_read_b128 v[60:63], v5 offset:30720
    v_mfma_f32_16x16x32_bf16 v[140:143], v[36:39], v[76:79], v[140:143]
    s_waitcnt lgkmcnt(4)
    v_mfma_f32_16x16x32_bf16 v[144:147], v[40:43], v[72:75], v[144:147]
    v_mfma_f32_16x16x32_bf16 v[152:155], v[40:43], v[76:79], v[152:155]
    s_barrier
    ds_read_b128 v[20:23], v4 offset:32768
    v_mfma_f32_16x16x32_bf16 v[148:151], v[44:47], v[72:75], v[148:151]
    ds_read_b128 v[36:39], v4 offset:34816
    v_mfma_f32_16x16x32_bf16 v[156:159], v[44:47], v[76:79], v[156:159]
    s_waitcnt lgkmcnt(4)
    v_mfma_f32_16x16x32_bf16 v[160:163], v[48:51], v[72:75], v[160:163]
    ds_read_b128 v[40:43], v4 offset:36864
    v_mfma_f32_16x16x32_bf16 v[168:171], v[48:51], v[76:79], v[168:171]
    v_mfma_f32_16x16x32_bf16 v[164:167], v[52:55], v[72:75], v[164:167]
    ds_read_b128 v[44:47], v4 offset:38912
    v_mfma_f32_16x16x32_bf16 v[172:175], v[52:55], v[76:79], v[172:175]
    s_waitcnt lgkmcnt(4)
    v_mfma_f32_16x16x32_bf16 v[176:179], v[56:59], v[72:75], v[176:179]
    ds_read_b128 v[48:51], v4 offset:40960
    v_mfma_f32_16x16x32_bf16 v[184:187], v[56:59], v[76:79], v[184:187]
    v_mfma_f32_16x16x32_bf16 v[180:183], v[60:63], v[72:75], v[180:183]
    ds_read_b128 v[52:55], v4 offset:43008
    v_mfma_f32_16x16x32_bf16 v[188:191], v[60:63], v[76:79], v[188:191]
    s_waitcnt lgkmcnt(4)
    v_mfma_f32_16x16x32_bf16 v[192:195], v[20:23], v[64:67], 0
    ds_read_b128 v[56:59], v4 offset:45056
    v_mfma_f32_16x16x32_bf16 v[200:203], v[20:23], v[68:71], 0
    v_mfma_f32_16x16x32_bf16 v[196:199], v[36:39], v[64:67], 0
    ds_read_b128 v[60:63], v4 offset:47104
    v_mfma_f32_16x16x32_bf16 v[204:207], v[36:39], v[68:71], 0
    s_waitcnt lgkmcnt(4)
    v_mfma_f32_16x16x32_bf16 v[208:211], v[40:43], v[64:67], 0
    ds_read_b128 v[20:23], v5 offset:32768
    v_mfma_f32_16x16x32_bf16 v[216:219], v[40:43], v[68:71], 0
    v_mfma_f32_16x16x32_bf16 v[212:215], v[44:47], v[64:67], 0
    ds_read_b128 v[36:39], v5 offset:34816
    v_mfma_f32_16x16x32_bf16 v[220:223], v[44:47], v[68:71], 0
    s_waitcnt lgkmcnt(4)
    v_mfma_f32_16x16x32_bf16 v[224:227], v[48:51], v[64:67], 0
    ds_read_b128 v[40:43], v5 offset:36864
    v_mfma_f32_16x16x32_bf16 v[232:235], v[48:51], v[68:71], 0
    v_mfma_f32_16x16x32_bf16 v[228:231], v[52:55], v[64:67], 0
    ds_read_b128 v[44:47], v5 offset:38912
    v_mfma_f32_16x16x32_bf16 v[236:239], v[52:55], v[68:71], 0
    s_waitcnt lgkmcnt(4)
    v_mfma_f32_16x16x32_bf16 v[240:243], v[56:59], v[64:67], 0
    ds_read_b128 v[48:51], v5 offset:40960
    v_mfma_f32_16x16x32_bf16 v[248:251], v[56:59], v[68:71], 0
    v_mfma_f32_16x16x32_bf16 v[244:247], v[60:63], v[64:67], 0
    ds_read_b128 v[52:55], v5 offset:43008
    v_mfma_f32_16x16x32_bf16 v[252:255], v[60:63], v[68:71], 0
    s_waitcnt lgkmcnt(4)
    v_mfma_f32_16x16x32_bf16 v[192:195], v[20:23], v[72:75], v[192:195]
    ds_read_b128 v[56:59], v5 offset:45056
    v_mfma_f32_16x16x32_bf16 v[200:203], v[20:23], v[76:79], v[200:203]
    v_mfma_f32_16x16x32_bf16 v[196:199], v[36:39], v[72:75], v[196:199]
    ds_read_b128 v[60:63], v5 offset:47104
    v_mfma_f32_16x16x32_bf16 v[204:207], v[36:39], v[76:79], v[204:207]
    s_waitcnt lgkmcnt(4)
    v_mfma_f32_16x16x32_bf16 v[208:211], v[40:43], v[72:75], v[208:211]
    v_mfma_f32_16x16x32_bf16 v[216:219], v[40:43], v[76:79], v[216:219]
    s_barrier
    ds_read_b128 v[80:83], v8 offset:49152
    ds_read_b128 v[84:87], v8 offset:51200
    ds_read_b128 v[20:23], v6 offset:0
    v_mfma_f32_16x16x32_bf16 v[212:215], v[44:47], v[72:75], v[212:215]
    ds_read_b128 v[36:39], v6 offset:2048
    v_mfma_f32_16x16x32_bf16 v[220:223], v[44:47], v[76:79], v[220:223]
    s_waitcnt lgkmcnt(6)
    v_mfma_f32_16x16x32_bf16 v[224:227], v[48:51], v[72:75], v[224:227]
    ds_read_b128 v[40:43], v6 offset:4096
    v_mfma_f32_16x16x32_bf16 v[232:235], v[48:51], v[76:79], v[232:235]
    v_mfma_f32_16x16x32_bf16 v[228:231], v[52:55], v[72:75], v[228:231]
    ds_read_b128 v[44:47], v6 offset:6144
    v_mfma_f32_16x16x32_bf16 v[236:239], v[52:55], v[76:79], v[236:239]
    s_waitcnt lgkmcnt(6)
    v_mfma_f32_16x16x32_bf16 v[240:243], v[56:59], v[72:75], v[240:243]
    ds_read_b128 v[48:51], v6 offset:8192
    v_mfma_f32_16x16x32_bf16 v[248:251], v[56:59], v[76:79], v[248:251]
    v_mfma_f32_16x16x32_bf16 v[244:247], v[60:63], v[72:75], v[244:247]
    ds_read_b128 v[52:55], v6 offset:10240
    v_mfma_f32_16x16x32_bf16 v[252:255], v[60:63], v[76:79], v[252:255]
    s_waitcnt lgkmcnt(4)
    v_mfma_f32_16x16x32_bf16 v[128:131], v[20:23], v[80:83], v[128:131]
    ds_read_b128 v[56:59], v6 offset:12288
    v_mfma_f32_16x16x32_bf16 v[136:139], v[20:23], v[84:87], v[136:139]
    v_mfma_f32_16x16x32_bf16 v[132:135], v[36:39], v[80:83], v[132:135]
    ds_read_b128 v[60:63], v6 offset:14336
    v_mfma_f32_16x16x32_bf16 v[140:143], v[36:39], v[84:87], v[140:143]
    s_waitcnt lgkmcnt(4)
    v_mfma_f32_16x16x32_bf16 v[144:147], v[40:43], v[80:83], v[144:147]
    ds_read_b128 v[88:91], v9 offset:49152
    ds_read_b128 v[92:95], v9 offset:51200
    v_mfma_f32_16x16x32_bf16 v[152:155], v[40:43], v[84:87], v[152:155]
    ds_read_b128 v[20:23], v7 offset:0
    v_mfma_f32_16x16x32_bf16 v[148:151], v[44:47], v[80:83], v[148:151]
    ds_read_b128 v[36:39], v7 offset:2048
    v_mfma_f32_16x16x32_bf16 v[156:159], v[44:47], v[84:87], v[156:159]
    s_waitcnt lgkmcnt(6)
    v_mfma_f32_16x16x32_bf16 v[160:163], v[48:51], v[80:83], v[160:163]
    ds_read_b128 v[40:43], v7 offset:4096
    v_mfma_f32_16x16x32_bf16 v[168:171], v[48:51], v[84:87], v[168:171]
    v_mfma_f32_16x16x32_bf16 v[164:167], v[52:55], v[80:83], v[164:167]
    ds_read_b128 v[44:47], v7 offset:6144
    v_mfma_f32_16x16x32_bf16 v[172:175], v[52:55], v[84:87], v[172:175]
    s_waitcnt lgkmcnt(6)
    v_mfma_f32_16x16x32_bf16 v[176:179], v[56:59], v[80:83], v[176:179]
    ds_read_b128 v[48:51], v7 offset:8192
    v_mfma_f32_16x16x32_bf16 v[184:187], v[56:59], v[84:87], v[184:187]
    v_mfma_f32_16x16x32_bf16 v[180:183], v[60:63], v[80:83], v[180:183]
    ds_read_b128 v[52:55], v7 offset:10240
    v_mfma_f32_16x16x32_bf16 v[188:191], v[60:63], v[84:87], v[188:191]
    s_waitcnt lgkmcnt(4)
    v_mfma_f32_16x16x32_bf16 v[128:131], v[20:23], v[88:91], v[128:131]
    ds_read_b128 v[56:59], v7 offset:12288
    v_mfma_f32_16x16x32_bf16 v[136:139], v[20:23], v[92:95], v[136:139]
    v_mfma_f32_16x16x32_bf16 v[132:135], v[36:39], v[88:91], v[132:135]
    ds_read_b128 v[60:63], v7 offset:14336
    v_mfma_f32_16x16x32_bf16 v[140:143], v[36:39], v[92:95], v[140:143]
    s_waitcnt lgkmcnt(4)
    v_mfma_f32_16x16x32_bf16 v[144:147], v[40:43], v[88:91], v[144:147]
    v_mfma_f32_16x16x32_bf16 v[152:155], v[40:43], v[92:95], v[152:155]
    s_barrier
    ds_read_b128 v[20:23], v6 offset:16384
    v_mfma_f32_16x16x32_bf16 v[148:151], v[44:47], v[88:91], v[148:151]
    ds_read_b128 v[36:39], v6 offset:18432
    v_mfma_f32_16x16x32_bf16 v[156:159], v[44:47], v[92:95], v[156:159]
    s_waitcnt lgkmcnt(4)
    v_mfma_f32_16x16x32_bf16 v[160:163], v[48:51], v[88:91], v[160:163]
    ds_read_b128 v[40:43], v6 offset:20480
    v_mfma_f32_16x16x32_bf16 v[168:171], v[48:51], v[92:95], v[168:171]
    v_mfma_f32_16x16x32_bf16 v[164:167], v[52:55], v[88:91], v[164:167]
    ds_read_b128 v[44:47], v6 offset:22528
    v_mfma_f32_16x16x32_bf16 v[172:175], v[52:55], v[92:95], v[172:175]
    s_waitcnt lgkmcnt(4)
    v_mfma_f32_16x16x32_bf16 v[176:179], v[56:59], v[88:91], v[176:179]
    ds_read_b128 v[48:51], v6 offset:24576
    v_mfma_f32_16x16x32_bf16 v[184:187], v[56:59], v[92:95], v[184:187]
    v_mfma_f32_16x16x32_bf16 v[180:183], v[60:63], v[88:91], v[180:183]
    ds_read_b128 v[52:55], v6 offset:26624
    v_mfma_f32_16x16x32_bf16 v[188:191], v[60:63], v[92:95], v[188:191]
    s_waitcnt lgkmcnt(4)
    v_mfma_f32_16x16x32_bf16 v[192:195], v[20:23], v[80:83], v[192:195]
    ds_read_b128 v[56:59], v6 offset:28672
    v_mfma_f32_16x16x32_bf16 v[200:203], v[20:23], v[84:87], v[200:203]
    v_mfma_f32_16x16x32_bf16 v[196:199], v[36:39], v[80:83], v[196:199]
    ds_read_b128 v[60:63], v6 offset:30720
    v_mfma_f32_16x16x32_bf16 v[204:207], v[36:39], v[84:87], v[204:207]
    s_waitcnt lgkmcnt(4)
    v_mfma_f32_16x16x32_bf16 v[208:211], v[40:43], v[80:83], v[208:211]
    ds_read_b128 v[20:23], v7 offset:16384
    v_mfma_f32_16x16x32_bf16 v[216:219], v[40:43], v[84:87], v[216:219]
    v_mfma_f32_16x16x32_bf16 v[212:215], v[44:47], v[80:83], v[212:215]
    ds_read_b128 v[36:39], v7 offset:18432
    v_mfma_f32_16x16x32_bf16 v[220:223], v[44:47], v[84:87], v[220:223]
    s_waitcnt lgkmcnt(4)
    v_mfma_f32_16x16x32_bf16 v[224:227], v[48:51], v[80:83], v[224:227]
    ds_read_b128 v[40:43], v7 offset:20480
    v_mfma_f32_16x16x32_bf16 v[232:235], v[48:51], v[84:87], v[232:235]
    v_mfma_f32_16x16x32_bf16 v[228:231], v[52:55], v[80:83], v[228:231]
    ds_read_b128 v[44:47], v7 offset:22528
    v_mfma_f32_16x16x32_bf16 v[236:239], v[52:55], v[84:87], v[236:239]
    s_waitcnt lgkmcnt(4)
    v_mfma_f32_16x16x32_bf16 v[240:243], v[56:59], v[80:83], v[240:243]
    ds_read_b128 v[48:51], v7 offset:24576
    v_mfma_f32_16x16x32_bf16 v[248:251], v[56:59], v[84:87], v[248:251]
    v_mfma_f32_16x16x32_bf16 v[244:247], v[60:63], v[80:83], v[244:247]
    ds_read_b128 v[52:55], v7 offset:26624
    v_mfma_f32_16x16x32_bf16 v[252:255], v[60:63], v[84:87], v[252:255]
    s_waitcnt lgkmcnt(4)
    v_mfma_f32_16x16x32_bf16 v[192:195], v[20:23], v[88:91], v[192:195]
    ds_read_b128 v[56:59], v7 offset:28672
    v_mfma_f32_16x16x32_bf16 v[200:203], v[20:23], v[92:95], v[200:203]
    v_mfma_f32_16x16x32_bf16 v[196:199], v[36:39], v[88:91], v[196:199]
    ds_read_b128 v[60:63], v7 offset:30720
    v_mfma_f32_16x16x32_bf16 v[204:207], v[36:39], v[92:95], v[204:207]
    s_waitcnt lgkmcnt(4)
    v_mfma_f32_16x16x32_bf16 v[208:211], v[40:43], v[88:91], v[208:211]
    v_mfma_f32_16x16x32_bf16 v[216:219], v[40:43], v[92:95], v[216:219]
    s_barrier
    ds_read_b128 v[64:67], v10 offset:32768
    ds_read_b128 v[68:71], v10 offset:34816
    ds_read_b128 v[20:23], v6 offset:49152
    v_mfma_f32_16x16x32_bf16 v[212:215], v[44:47], v[88:91], v[212:215]
    ds_read_b128 v[36:39], v6 offset:51200
    v_mfma_f32_16x16x32_bf16 v[220:223], v[44:47], v[92:95], v[220:223]
    s_waitcnt lgkmcnt(6)
    v_mfma_f32_16x16x32_bf16 v[224:227], v[48:51], v[88:91], v[224:227]
    ds_read_b128 v[40:43], v6 offset:53248
    v_mfma_f32_16x16x32_bf16 v[232:235], v[48:51], v[92:95], v[232:235]
    v_mfma_f32_16x16x32_bf16 v[228:231], v[52:55], v[88:91], v[228:231]
    ds_read_b128 v[44:47], v6 offset:55296
    v_mfma_f32_16x16x32_bf16 v[236:239], v[52:55], v[92:95], v[236:239]
    s_waitcnt lgkmcnt(6)
    v_mfma_f32_16x16x32_bf16 v[240:243], v[56:59], v[88:91], v[240:243]
    ds_read_b128 v[48:51], v6 offset:57344
    v_mfma_f32_16x16x32_bf16 v[248:251], v[56:59], v[92:95], v[248:251]
    v_mfma_f32_16x16x32_bf16 v[244:247], v[60:63], v[88:91], v[244:247]
    ds_read_b128 v[52:55], v6 offset:59392
    v_mfma_f32_16x16x32_bf16 v[252:255], v[60:63], v[92:95], v[252:255]
    s_waitcnt lgkmcnt(4)
    v_mfma_f32_16x16x32_bf16 v[128:131], v[20:23], v[64:67], v[128:131]
    ds_read_b128 v[56:59], v6 offset:61440
    v_mfma_f32_16x16x32_bf16 v[136:139], v[20:23], v[68:71], v[136:139]
    v_mfma_f32_16x16x32_bf16 v[132:135], v[36:39], v[64:67], v[132:135]
    ds_read_b128 v[60:63], v6 offset:63488
    v_mfma_f32_16x16x32_bf16 v[140:143], v[36:39], v[68:71], v[140:143]
    s_waitcnt lgkmcnt(4)
    v_mfma_f32_16x16x32_bf16 v[144:147], v[40:43], v[64:67], v[144:147]
    ds_read_b128 v[72:75], v11 offset:32768
    ds_read_b128 v[76:79], v11 offset:34816
    v_mfma_f32_16x16x32_bf16 v[152:155], v[40:43], v[68:71], v[152:155]
    ds_read_b128 v[20:23], v7 offset:49152
    v_mfma_f32_16x16x32_bf16 v[148:151], v[44:47], v[64:67], v[148:151]
    ds_read_b128 v[36:39], v7 offset:51200
    v_mfma_f32_16x16x32_bf16 v[156:159], v[44:47], v[68:71], v[156:159]
    s_waitcnt lgkmcnt(6)
    v_mfma_f32_16x16x32_bf16 v[160:163], v[48:51], v[64:67], v[160:163]
    ds_read_b128 v[40:43], v7 offset:53248
    v_mfma_f32_16x16x32_bf16 v[168:171], v[48:51], v[68:71], v[168:171]
    v_mfma_f32_16x16x32_bf16 v[164:167], v[52:55], v[64:67], v[164:167]
    ds_read_b128 v[44:47], v7 offset:55296
    v_mfma_f32_16x16x32_bf16 v[172:175], v[52:55], v[68:71], v[172:175]
    s_waitcnt lgkmcnt(6)
    v_mfma_f32_16x16x32_bf16 v[176:179], v[56:59], v[64:67], v[176:179]
    ds_read_b128 v[48:51], v7 offset:57344
    v_mfma_f32_16x16x32_bf16 v[184:187], v[56:59], v[68:71], v[184:187]
    v_mfma_f32_16x16x32_bf16 v[180:183], v[60:63], v[64:67], v[180:183]
    ds_read_b128 v[52:55], v7 offset:59392
    v_mfma_f32_16x16x32_bf16 v[188:191], v[60:63], v[68:71], v[188:191]
    s_waitcnt lgkmcnt(4)
    v_mfma_f32_16x16x32_bf16 v[128:131], v[20:23], v[72:75], v[128:131]
    ds_read_b128 v[56:59], v7 offset:61440
    v_mfma_f32_16x16x32_bf16 v[136:139], v[20:23], v[76:79], v[136:139]
    v_mfma_f32_16x16x32_bf16 v[132:135], v[36:39], v[72:75], v[132:135]
    ds_read_b128 v[60:63], v7 offset:63488
    v_mfma_f32_16x16x32_bf16 v[140:143], v[36:39], v[76:79], v[140:143]
    s_waitcnt lgkmcnt(4)
    v_mfma_f32_16x16x32_bf16 v[144:147], v[40:43], v[72:75], v[144:147]
    v_mfma_f32_16x16x32_bf16 v[152:155], v[40:43], v[76:79], v[152:155]
    s_barrier
    ds_read_b128 v[20:23], v4 offset:0
    v_mfma_f32_16x16x32_bf16 v[148:151], v[44:47], v[72:75], v[148:151]
    ds_read_b128 v[36:39], v4 offset:2048
    v_mfma_f32_16x16x32_bf16 v[156:159], v[44:47], v[76:79], v[156:159]
    s_waitcnt lgkmcnt(4)
    v_mfma_f32_16x16x32_bf16 v[160:163], v[48:51], v[72:75], v[160:163]
    ds_read_b128 v[40:43], v4 offset:4096
    v_mfma_f32_16x16x32_bf16 v[168:171], v[48:51], v[76:79], v[168:171]
    v_mfma_f32_16x16x32_bf16 v[164:167], v[52:55], v[72:75], v[164:167]
    ds_read_b128 v[44:47], v4 offset:6144
    v_mfma_f32_16x16x32_bf16 v[172:175], v[52:55], v[76:79], v[172:175]
    s_waitcnt lgkmcnt(4)
    v_mfma_f32_16x16x32_bf16 v[176:179], v[56:59], v[72:75], v[176:179]
    ds_read_b128 v[48:51], v4 offset:8192
    v_mfma_f32_16x16x32_bf16 v[184:187], v[56:59], v[76:79], v[184:187]
    v_mfma_f32_16x16x32_bf16 v[180:183], v[60:63], v[72:75], v[180:183]
    ds_read_b128 v[52:55], v4 offset:10240
    v_mfma_f32_16x16x32_bf16 v[188:191], v[60:63], v[76:79], v[188:191]
    s_waitcnt lgkmcnt(4)
    v_mfma_f32_16x16x32_bf16 v[192:195], v[20:23], v[64:67], v[192:195]
    ds_read_b128 v[56:59], v4 offset:12288
    v_mfma_f32_16x16x32_bf16 v[200:203], v[20:23], v[68:71], v[200:203]
    v_mfma_f32_16x16x32_bf16 v[196:199], v[36:39], v[64:67], v[196:199]
    ds_read_b128 v[60:63], v4 offset:14336
    v_mfma_f32_16x16x32_bf16 v[204:207], v[36:39], v[68:71], v[204:207]
    s_waitcnt lgkmcnt(4)
    v_mfma_f32_16x16x32_bf16 v[208:211], v[40:43], v[64:67], v[208:211]
    ds_read_b128 v[20:23], v5 offset:0
    v_mfma_f32_16x16x32_bf16 v[216:219], v[40:43], v[68:71], v[216:219]
    v_mfma_f32_16x16x32_bf16 v[212:215], v[44:47], v[64:67], v[212:215]
    ds_read_b128 v[36:39], v5 offset:2048
    v_mfma_f32_16x16x32_bf16 v[220:223], v[44:47], v[68:71], v[220:223]
    s_waitcnt lgkmcnt(4)
    v_mfma_f32_16x16x32_bf16 v[224:227], v[48:51], v[64:67], v[224:227]
    ds_read_b128 v[40:43], v5 offset:4096
    v_mfma_f32_16x16x32_bf16 v[232:235], v[48:51], v[68:71], v[232:235]
    v_mfma_f32_16x16x32_bf16 v[228:231], v[52:55], v[64:67], v[228:231]
    ds_read_b128 v[44:47], v5 offset:6144
    v_mfma_f32_16x16x32_bf16 v[236:239], v[52:55], v[68:71], v[236:239]
    s_waitcnt lgkmcnt(4)
    v_mfma_f32_16x16x32_bf16 v[240:243], v[56:59], v[64:67], v[240:243]
    ds_read_b128 v[48:51], v5 offset:8192
    v_mfma_f32_16x16x32_bf16 v[248:251], v[56:59], v[68:71], v[248:251]
    v_mfma_f32_16x16x32_bf16 v[244:247], v[60:63], v[64:67], v[244:247]
    ds_read_b128 v[52:55], v5 offset:10240
    v_mfma_f32_16x16x32_bf16 v[252:255], v[60:63], v[68:71], v[252:255]
    s_waitcnt lgkmcnt(4)
    v_mfma_f32_16x16x32_bf16 v[192:195], v[20:23], v[72:75], v[192:195]
    ds_read_b128 v[56:59], v5 offset:12288
    v_mfma_f32_16x16x32_bf16 v[200:203], v[20:23], v[76:79], v[200:203]
    v_mfma_f32_16x16x32_bf16 v[196:199], v[36:39], v[72:75], v[196:199]
    ds_read_b128 v[60:63], v5 offset:14336
    v_mfma_f32_16x16x32_bf16 v[204:207], v[36:39], v[76:79], v[204:207]
    s_waitcnt lgkmcnt(4)
    v_mfma_f32_16x16x32_bf16 v[208:211], v[40:43], v[72:75], v[208:211]
    v_mfma_f32_16x16x32_bf16 v[216:219], v[40:43], v[76:79], v[216:219]
    s_barrier
    ds_read_b128 v[80:83], v8 offset:16384
    ds_read_b128 v[84:87], v8 offset:18432
    ds_read_b128 v[20:23], v4 offset:32768
    v_mfma_f32_16x16x32_bf16 v[212:215], v[44:47], v[72:75], v[212:215]
    ds_read_b128 v[36:39], v4 offset:34816
    v_mfma_f32_16x16x32_bf16 v[220:223], v[44:47], v[76:79], v[220:223]
    s_waitcnt lgkmcnt(6)
    v_mfma_f32_16x16x32_bf16 v[224:227], v[48:51], v[72:75], v[224:227]
    ds_read_b128 v[40:43], v4 offset:36864
    v_mfma_f32_16x16x32_bf16 v[232:235], v[48:51], v[76:79], v[232:235]
    v_mfma_f32_16x16x32_bf16 v[228:231], v[52:55], v[72:75], v[228:231]
    ds_read_b128 v[44:47], v4 offset:38912
    v_mfma_f32_16x16x32_bf16 v[236:239], v[52:55], v[76:79], v[236:239]
    s_waitcnt lgkmcnt(6)
    v_mfma_f32_16x16x32_bf16 v[240:243], v[56:59], v[72:75], v[240:243]
    ds_read_b128 v[48:51], v4 offset:40960
    v_mfma_f32_16x16x32_bf16 v[248:251], v[56:59], v[76:79], v[248:251]
    v_mfma_f32_16x16x32_bf16 v[244:247], v[60:63], v[72:75], v[244:247]
    ds_read_b128 v[52:55], v4 offset:43008
    v_mfma_f32_16x16x32_bf16 v[252:255], v[60:63], v[76:79], v[252:255]
    s_waitcnt lgkmcnt(4)
    v_mfma_f32_16x16x32_bf16 v[128:131], v[20:23], v[80:83], v[128:131]
    ds_read_b128 v[56:59], v4 offset:45056
    v_mfma_f32_16x16x32_bf16 v[136:139], v[20:23], v[84:87], v[136:139]
    v_mfma_f32_16x16x32_bf16 v[132:135], v[36:39], v[80:83], v[132:135]
    ds_read_b128 v[60:63], v4 offset:47104
    v_mfma_f32_16x16x32_bf16 v[140:143], v[36:39], v[84:87], v[140:143]
    s_waitcnt lgkmcnt(4)
    v_mfma_f32_16x16x32_bf16 v[144:147], v[40:43], v[80:83], v[144:147]
    ds_read_b128 v[88:91], v9 offset:16384
    ds_read_b128 v[92:95], v9 offset:18432
    v_mfma_f32_16x16x32_bf16 v[152:155], v[40:43], v[84:87], v[152:155]
    ds_read_b128 v[20:23], v5 offset:32768
    v_mfma_f32_16x16x32_bf16 v[148:151], v[44:47], v[80:83], v[148:151]
    ds_read_b128 v[36:39], v5 offset:34816
    v_mfma_f32_16x16x32_bf16 v[156:159], v[44:47], v[84:87], v[156:159]
    s_waitcnt lgkmcnt(6)
    v_mfma_f32_16x16x32_bf16 v[160:163], v[48:51], v[80:83], v[160:163]
    ds_read_b128 v[40:43], v5 offset:36864
    v_mfma_f32_16x16x32_bf16 v[168:171], v[48:51], v[84:87], v[168:171]
    v_mfma_f32_16x16x32_bf16 v[164:167], v[52:55], v[80:83], v[164:167]
    ds_read_b128 v[44:47], v5 offset:38912
    v_mfma_f32_16x16x32_bf16 v[172:175], v[52:55], v[84:87], v[172:175]
    s_waitcnt lgkmcnt(6)
    v_mfma_f32_16x16x32_bf16 v[176:179], v[56:59], v[80:83], v[176:179]
    ds_read_b128 v[48:51], v5 offset:40960
    v_mfma_f32_16x16x32_bf16 v[184:187], v[56:59], v[84:87], v[184:187]
    v_mfma_f32_16x16x32_bf16 v[180:183], v[60:63], v[80:83], v[180:183]
    ds_read_b128 v[52:55], v5 offset:43008
    v_mfma_f32_16x16x32_bf16 v[188:191], v[60:63], v[84:87], v[188:191]
    s_waitcnt lgkmcnt(4)
    v_mfma_f32_16x16x32_bf16 v[128:131], v[20:23], v[88:91], v[128:131]
    ds_read_b128 v[56:59], v5 offset:45056
    v_mfma_f32_16x16x32_bf16 v[136:139], v[20:23], v[92:95], v[136:139]
    v_mfma_f32_16x16x32_bf16 v[132:135], v[36:39], v[88:91], v[132:135]
    ds_read_b128 v[60:63], v5 offset:47104
    v_mfma_f32_16x16x32_bf16 v[140:143], v[36:39], v[92:95], v[140:143]
    s_waitcnt lgkmcnt(4)
    v_mfma_f32_16x16x32_bf16 v[144:147], v[40:43], v[88:91], v[144:147]
    v_mfma_f32_16x16x32_bf16 v[152:155], v[40:43], v[92:95], v[152:155]
    s_barrier
    ds_read_b128 v[20:23], v4 offset:49152
    v_mfma_f32_16x16x32_bf16 v[148:151], v[44:47], v[88:91], v[148:151]
    ds_read_b128 v[36:39], v4 offset:51200
    v_mfma_f32_16x16x32_bf16 v[156:159], v[44:47], v[92:95], v[156:159]
    s_waitcnt lgkmcnt(4)
    v_mfma_f32_16x16x32_bf16 v[160:163], v[48:51], v[88:91], v[160:163]
    ds_read_b128 v[40:43], v4 offset:53248
    v_mfma_f32_16x16x32_bf16 v[168:171], v[48:51], v[92:95], v[168:171]
    v_mfma_f32_16x16x32_bf16 v[164:167], v[52:55], v[88:91], v[164:167]
    ds_read_b128 v[44:47], v4 offset:55296
    v_mfma_f32_16x16x32_bf16 v[172:175], v[52:55], v[92:95], v[172:175]
    s_waitcnt lgkmcnt(4)
    v_mfma_f32_16x16x32_bf16 v[176:179], v[56:59], v[88:91], v[176:179]
    ds_read_b128 v[48:51], v4 offset:57344
    v_mfma_f32_16x16x32_bf16 v[184:187], v[56:59], v[92:95], v[184:187]
    v_mfma_f32_16x16x32_bf16 v[180:183], v[60:63], v[88:91], v[180:183]
    ds_read_b128 v[52:55], v4 offset:59392
    v_mfma_f32_16x16x32_bf16 v[188:191], v[60:63], v[92:95], v[188:191]
    s_waitcnt lgkmcnt(4)
    v_mfma_f32_16x16x32_bf16 v[192:195], v[20:23], v[80:83], v[192:195]
    ds_read_b128 v[56:59], v4 offset:61440
    v_mfma_f32_16x16x32_bf16 v[200:203], v[20:23], v[84:87], v[200:203]
    v_mfma_f32_16x16x32_bf16 v[196:199], v[36:39], v[80:83], v[196:199]
    ds_read_b128 v[60:63], v4 offset:63488
    v_mfma_f32_16x16x32_bf16 v[204:207], v[36:39], v[84:87], v[204:207]
    s_waitcnt lgkmcnt(4)
    v_mfma_f32_16x16x32_bf16 v[208:211], v[40:43], v[80:83], v[208:211]
    ds_read_b128 v[20:23], v5 offset:49152
    v_mfma_f32_16x16x32_bf16 v[216:219], v[40:43], v[84:87], v[216:219]
    v_mfma_f32_16x16x32_bf16 v[212:215], v[44:47], v[80:83], v[212:215]
    ds_read_b128 v[36:39], v5 offset:51200
    v_mfma_f32_16x16x32_bf16 v[220:223], v[44:47], v[84:87], v[220:223]
    s_waitcnt lgkmcnt(4)
    v_mfma_f32_16x16x32_bf16 v[224:227], v[48:51], v[80:83], v[224:227]
    ds_read_b128 v[40:43], v5 offset:53248
    v_mfma_f32_16x16x32_bf16 v[232:235], v[48:51], v[84:87], v[232:235]
    v_mfma_f32_16x16x32_bf16 v[228:231], v[52:55], v[80:83], v[228:231]
    ds_read_b128 v[44:47], v5 offset:55296
    v_mfma_f32_16x16x32_bf16 v[236:239], v[52:55], v[84:87], v[236:239]
    s_waitcnt lgkmcnt(4)
    v_mfma_f32_16x16x32_bf16 v[240:243], v[56:59], v[80:83], v[240:243]
    ds_read_b128 v[48:51], v5 offset:57344
    v_mfma_f32_16x16x32_bf16 v[248:251], v[56:59], v[84:87], v[248:251]
    v_mfma_f32_16x16x32_bf16 v[244:247], v[60:63], v[80:83], v[244:247]
    ds_read_b128 v[52:55], v5 offset:59392
    v_mfma_f32_16x16x32_bf16 v[252:255], v[60:63], v[84:87], v[252:255]
    s_waitcnt lgkmcnt(4)
    v_mfma_f32_16x16x32_bf16 v[192:195], v[20:23], v[88:91], v[192:195]
    ds_read_b128 v[56:59], v5 offset:61440
    v_mfma_f32_16x16x32_bf16 v[200:203], v[20:23], v[92:95], v[200:203]
    v_mfma_f32_16x16x32_bf16 v[196:199], v[36:39], v[88:91], v[196:199]
    ds_read_b128 v[60:63], v5 offset:63488
    v_mfma_f32_16x16x32_bf16 v[204:207], v[36:39], v[92:95], v[204:207]
    s_waitcnt lgkmcnt(4)
    v_mfma_f32_16x16x32_bf16 v[208:211], v[40:43], v[88:91], v[208:211]
    v_mfma_f32_16x16x32_bf16 v[216:219], v[40:43], v[92:95], v[216:219]
    s_barrier
    v_mfma_f32_16x16x32_bf16 v[212:215], v[44:47], v[88:91], v[212:215]
    v_mfma_f32_16x16x32_bf16 v[220:223], v[44:47], v[92:95], v[220:223]
    s_waitcnt lgkmcnt(2)
    v_mfma_f32_16x16x32_bf16 v[224:227], v[48:51], v[88:91], v[224:227]
    v_mfma_f32_16x16x32_bf16 v[232:235], v[48:51], v[92:95], v[232:235]
    v_mfma_f32_16x16x32_bf16 v[228:231], v[52:55], v[88:91], v[228:231]
    v_mfma_f32_16x16x32_bf16 v[236:239], v[52:55], v[92:95], v[236:239]
    s_waitcnt lgkmcnt(1)
    v_mfma_f32_16x16x32_bf16 v[240:243], v[56:59], v[88:91], v[240:243]
    v_mfma_f32_16x16x32_bf16 v[248:251], v[56:59], v[92:95], v[248:251]
    s_waitcnt lgkmcnt(0)
    v_mfma_f32_16x16x32_bf16 v[244:247], v[60:63], v[88:91], v[244:247]
    v_mfma_f32_16x16x32_bf16 v[252:255], v[60:63], v[92:95], v[252:255]
    s_setprio 0
    v_max3_f32 v48, v128, v129, v130
    v_max3_f32 v49, v136, v137, v138
    v_max3_f32 v48, v48, v131, v132
    v_max3_f32 v49, v49, v139, v140
    v_max3_f32 v48, v48, v133, v134
    v_max3_f32 v49, v49, v141, v142
    v_max3_f32 v48, v48, v135, v144
    v_max3_f32 v49, v49, v143, v152
    v_max3_f32 v48, v48, v145, v146
    v_max3_f32 v49, v49, v153, v154
    v_max3_f32 v48, v48, v147, v148
    v_max3_f32 v49, v49, v155, v156
    v_max3_f32 v48, v48, v149, v150
    v_max3_f32 v49, v49, v157, v158
    v_max3_f32 v48, v48, v151, v160
    v_max3_f32 v49, v49, v159, v168
    v_max3_f32 v48, v48, v161, v162
    v_max3_f32 v49, v49, v169, v170
    v_max3_f32 v48, v48, v163, v164
    v_max3_f32 v49, v49, v171, v172
    v_max3_f32 v48, v48, v165, v166
    v_max3_f32 v49, v49, v173, v174
    v_max3_f32 v48, v48, v167, v176
    v_max3_f32 v49, v49, v175, v184
    v_max3_f32 v48, v48, v177, v178
    v_max3_f32 v49, v49, v185, v186
    v_max3_f32 v48, v48, v179, v180
    v_max3_f32 v49, v49, v187, v188
    v_max3_f32 v48, v48, v181, v182
    v_max3_f32 v49, v49, v189, v190
    v_max3_f32 v48, v48, v183, v192
    v_max3_f32 v49, v49, v191, v200
    v_max3_f32 v48, v48, v193, v194
    v_max3_f32 v49, v49, v201, v202
    v_max3_f32 v48, v48, v195, v196
    v_max3_f32 v49, v49, v203, v204
    v_max3_f32 v48, v48, v197, v198
    v_max3_f32 v49, v49, v205, v206
    v_max3_f32 v48, v48, v199, v208
    v_max3_f32 v49, v49, v207, v216
    s_barrier
    v_max3_f32 v48, v48, v209, v210
    v_max3_f32 v49, v49, v217, v218
    v_max3_f32 v48, v48, v211, v212
    v_max3_f32 v49, v49, v219, v220
    v_max3_f32 v48, v48, v213, v214
    v_max3_f32 v49, v49, v221, v222
    v_max3_f32 v48, v48, v215, v224
    v_max3_f32 v49, v49, v223, v232
    v_max3_f32 v48, v48, v225, v226
    v_max3_f32 v49, v49, v233, v234
    v_max3_f32 v48, v48, v227, v228
    v_max3_f32 v49, v49, v235, v236
    v_max3_f32 v48, v48, v229, v230
    v_max3_f32 v49, v49, v237, v238
    v_max3_f32 v48, v48, v231, v240
    v_max3_f32 v49, v49, v239, v248
    v_max3_f32 v48, v48, v241, v242
    v_max3_f32 v49, v49, v249, v250
    v_max3_f32 v48, v48, v243, v244
    v_max3_f32 v49, v49, v251, v252
    v_max3_f32 v48, v48, v245, v246
    v_max3_f32 v49, v49, v253, v254
    v_max_f32 v48, v48, v247
    v_max_f32 v49, v49, v255
    s_nop 1
    v_permlane16_swap_b32 v48, v49
    v_max_f32 v48, v48, v49
    v_mov_b32 v49, v48
    s_nop 1
    v_permlane32_swap_b32 v48, v49
    v_max_f32 v48, v48, v49
    v_mul_f32 v26, s42, v48
    ds_write_b32 v25, v26 offset:24576
    v_mov_b32 v34, v26
    v_mov_b32 v35, v26
    s_nop 1
    v_permlane16_swap_b32 v34, v35
    v_fma_f32 v128, v128, s42, -v34
    v_fma_f32 v129, v129, s42, -v34
    v_fma_f32 v130, v130, s42, -v34
    v_fma_f32 v131, v131, s42, -v34
    v_exp_f32 v128, v128
    v_exp_f32 v129, v129
    v_exp_f32 v130, v130
    v_exp_f32 v131, v131
    v_fma_f32 v132, v132, s42, -v34
    v_fma_f32 v133, v133, s42, -v34
    v_fma_f32 v134, v134, s42, -v34
    v_fma_f32 v135, v135, s42, -v34
    v_exp_f32 v132, v132
    v_exp_f32 v133, v133
    v_exp_f32 v134, v134
    v_exp_f32 v135, v135
    v_cvt_pk_bf16_f32 v64, v128, v129
    v_cvt_pk_bf16_f32 v65, v130, v131
    v_fma_f32 v136, v136, s42, -v35
    v_fma_f32 v137, v137, s42, -v35
    v_fma_f32 v138, v138, s42, -v35
    v_fma_f32 v139, v139, s42, -v35
    v_exp_f32 v136, v136
    v_exp_f32 v137, v137
    v_exp_f32 v138, v138
    s_waitcnt lgkmcnt(0)
    s_barrier
    v_exp_f32 v139, v139
    v_cvt_pk_bf16_f32 v66, v132, v133
    v_cvt_pk_bf16_f32 v67, v134, v135
    v_fma_f32 v140, v140, s42, -v35
    v_fma_f32 v141, v141, s42, -v35
    v_fma_f32 v142, v142, s42, -v35
    v_fma_f32 v143, v143, s42, -v35
    v_exp_f32 v140, v140
    v_exp_f32 v141, v141
    v_exp_f32 v142, v142
    v_exp_f32 v143, v143
    v_cvt_pk_bf16_f32 v68, v136, v137
    v_cvt_pk_bf16_f32 v69, v138, v139
    v_fma_f32 v144, v144, s42, -v34
    v_fma_f32 v145, v145, s42, -v34
    v_fma_f32 v146, v146, s42, -v34
    v_fma_f32 v147, v147, s42, -v34
    v_exp_f32 v144, v144
    v_exp_f32 v145, v145
    v_exp_f32 v146, v146
    v_exp_f32 v147, v147
    v_cvt_pk_bf16_f32 v70, v140, v141
    v_cvt_pk_bf16_f32 v71, v142, v143
    v_fma_f32 v148, v148, s42, -v34
    v_fma_f32 v149, v149, s42, -v34
    v_fma_f32 v150, v150, s42, -v34
    v_fma_f32 v151, v151, s42, -v34
    v_exp_f32 v148, v148
    v_exp_f32 v149, v149
    v_exp_f32 v150, v150
    v_exp_f32 v151, v151
    v_cvt_pk_bf16_f32 v72, v144, v145
    v_cvt_pk_bf16_f32 v73, v146, v147
    v_fma_f32 v152, v152, s42, -v35
    v_fma_f32 v153, v153, s42, -v35
    v_fma_f32 v154, v154, s42, -v35
    v_fma_f32 v155, v155, s42, -v35
    v_exp_f32 v152, v152
    v_exp_f32 v153, v153
    v_exp_f32 v154, v154
    v_exp_f32 v155, v155
    v_cvt_pk_bf16_f32 v74, v148, v149
    v_cvt_pk_bf16_f32 v75, v150, v151
    v_fma_f32 v156, v156, s42, -v35
    v_fma_f32 v157, v157, s42, -v35
    v_fma_f32 v158, v158, s42, -v35
    v_fma_f32 v159, v159, s42, -v35
    v_exp_f32 v156, v156
    v_exp_f32 v157, v157
    v_exp_f32 v158, v158
    v_exp_f32 v159, v159
    v_cvt_pk_bf16_f32 v76, v152, v153
    v_cvt_pk_bf16_f32 v77, v154, v155
    v_fma_f32 v160, v160, s42, -v34
    v_fma_f32 v161, v161, s42, -v34
    v_fma_f32 v162, v162, s42, -v34
    v_fma_f32 v163, v163, s42, -v34
    v_exp_f32 v160, v160
    v_exp_f32 v161, v161
    v_exp_f32 v162, v162
    v_exp_f32 v163, v163
    v_cvt_pk_bf16_f32 v78, v156, v157
    v_cvt_pk_bf16_f32 v79, v158, v159
    v_fma_f32 v164, v164, s42, -v34
    v_fma_f32 v165, v165, s42, -v34
    v_fma_f32 v166, v166, s42, -v34
    v_fma_f32 v167, v167, s42, -v34
    v_exp_f32 v164, v164
    v_exp_f32 v165, v165
    v_exp_f32 v166, v166
    v_exp_f32 v167, v167
    v_cvt_pk_bf16_f32 v80, v160, v161
    v_cvt_pk_bf16_f32 v81, v162, v163
    v_fma_f32 v168, v168, s42, -v35
    v_fma_f32 v169, v169, s42, -v35
    v_fma_f32 v170, v170, s42, -v35
    v_fma_f32 v171, v171, s42, -v35
    v_exp_f32 v168, v168
    v_exp_f32 v169, v169
    v_exp_f32 v170, v170
    v_exp_f32 v171, v171
    v_cvt_pk_bf16_f32 v82, v164, v165
    v_cvt_pk_bf16_f32 v83, v166, v167
    v_fma_f32 v172, v172, s42, -v35
    v_fma_f32 v173, v173, s42, -v35
    v_fma_f32 v174, v174, s42, -v35
    v_fma_f32 v175, v175, s42, -v35
    v_exp_f32 v172, v172
    v_exp_f32 v173, v173
    v_exp_f32 v174, v174
    v_exp_f32 v175, v175
    v_cvt_pk_bf16_f32 v84, v168, v169
    v_cvt_pk_bf16_f32 v85, v170, v171
    v_fma_f32 v176, v176, s42, -v34
    v_fma_f32 v177, v177, s42, -v34
    v_fma_f32 v178, v178, s42, -v34
    v_fma_f32 v179, v179, s42, -v34
    v_exp_f32 v176, v176
    v_exp_f32 v177, v177
    s_barrier
    v_exp_f32 v178, v178
    v_exp_f32 v179, v179
    v_cvt_pk_bf16_f32 v86, v172, v173
    v_cvt_pk_bf16_f32 v87, v174, v175
    v_fma_f32 v180, v180, s42, -v34
    v_fma_f32 v181, v181, s42, -v34
    v_fma_f32 v182, v182, s42, -v34
    v_fma_f32 v183, v183, s42, -v34
    v_exp_f32 v180, v180
    v_exp_f32 v181, v181
    v_exp_f32 v182, v182
    v_exp_f32 v183, v183
    v_cvt_pk_bf16_f32 v88, v176, v177
    v_cvt_pk_bf16_f32 v89, v178, v179
    v_fma_f32 v184, v184, s42, -v35
    v_fma_f32 v185, v185, s42, -v35
    v_fma_f32 v186, v186, s42, -v35
    v_fma_f32 v187, v187, s42, -v35
    v_exp_f32 v184, v184
    v_exp_f32 v185, v185
    v_exp_f32 v186, v186
    v_exp_f32 v187, v187
    v_cvt_pk_bf16_f32 v90, v180, v181
    v_cvt_pk_bf16_f32 v91, v182, v183
    v_fma_f32 v188, v188, s42, -v35
    v_fma_f32 v189, v189, s42, -v35
    v_fma_f32 v190, v190, s42, -v35
    v_fma_f32 v191, v191, s42, -v35
    v_exp_f32 v188, v188
    v_exp_f32 v189, v189
    v_exp_f32 v190, v190
    v_exp_f32 v191, v191
    v_cvt_pk_bf16_f32 v92, v184, v185
    v_cvt_pk_bf16_f32 v93, v186, v187
    v_fma_f32 v192, v192, s42, -v34
    v_fma_f32 v193, v193, s42, -v34
    v_fma_f32 v194, v194, s42, -v34
    v_fma_f32 v195, v195, s42, -v34
    v_exp_f32 v192, v192
    v_exp_f32 v193, v193
    v_exp_f32 v194, v194
    v_exp_f32 v195, v195
    v_cvt_pk_bf16_f32 v94, v188, v189
    v_cvt_pk_bf16_f32 v95, v190, v191
    v_fma_f32 v196, v196, s42, -v34
    v_fma_f32 v197, v197, s42, -v34
    v_fma_f32 v198, v198, s42, -v34
    v_fma_f32 v199, v199, s42, -v34
    v_exp_f32 v196, v196
    v_exp_f32 v197, v197
    v_exp_f32 v198, v198
    v_exp_f32 v199, v199
    v_cvt_pk_bf16_f32 v96, v192, v193
    v_cvt_pk_bf16_f32 v97, v194, v195
    v_fma_f32 v200, v200, s42, -v35
    v_fma_f32 v201, v201, s42, -v35
    v_fma_f32 v202, v202, s42, -v35
    v_fma_f32 v203, v203, s42, -v35
    v_exp_f32 v200, v200
    v_exp_f32 v201, v201
    v_exp_f32 v202, v202
    v_exp_f32 v203, v203
    v_cvt_pk_bf16_f32 v98, v196, v197
    v_cvt_pk_bf16_f32 v99, v198, v199
    v_fma_f32 v204, v204, s42, -v35
    v_fma_f32 v205, v205, s42, -v35
    v_fma_f32 v206, v206, s42, -v35
    v_fma_f32 v207, v207, s42, -v35
    v_exp_f32 v204, v204
    v_exp_f32 v205, v205
    v_exp_f32 v206, v206
    v_exp_f32 v207, v207
    v_cvt_pk_bf16_f32 v100, v200, v201
    v_cvt_pk_bf16_f32 v101, v202, v203
    v_fma_f32 v208, v208, s42, -v34
    v_fma_f32 v209, v209, s42, -v34
    v_fma_f32 v210, v210, s42, -v34
    v_fma_f32 v211, v211, s42, -v34
    v_exp_f32 v208, v208
    v_exp_f32 v209, v209
    v_exp_f32 v210, v210
    v_exp_f32 v211, v211
    v_cvt_pk_bf16_f32 v102, v204, v205
    v_cvt_pk_bf16_f32 v103, v206, v207
    v_fma_f32 v212, v212, s42, -v34
    v_fma_f32 v213, v213, s42, -v34
    v_fma_f32 v214, v214, s42, -v34
    v_fma_f32 v215, v215, s42, -v34
    v_exp_f32 v212, v212
    v_exp_f32 v213, v213
    v_exp_f32 v214, v214
    v_exp_f32 v215, v215
    v_cvt_pk_bf16_f32 v104, v208, v209
    v_cvt_pk_bf16_f32 v105, v210, v211
    v_fma_f32 v216, v216, s42, -v35
    v_fma_f32 v217, v217, s42, -v35
    v_fma_f32 v218, v218, s42, -v35
    v_fma_f32 v219, v219, s42, -v35
    v_exp_f32 v216, v216
    v_exp_f32 v217, v217
    s_barrier
    v_exp_f32 v218, v218
    v_exp_f32 v219, v219
    v_cvt_pk_bf16_f32 v106, v212, v213
    v_cvt_pk_bf16_f32 v107, v214, v215
    v_fma_f32 v220, v220, s42, -v35
    v_fma_f32 v221, v221, s42, -v35
    v_fma_f32 v222, v222, s42, -v35
    v_fma_f32 v223, v223, s42, -v35
    v_exp_f32 v220, v220
    v_exp_f32 v221, v221
    v_exp_f32 v222, v222
    v_exp_f32 v223, v223
    v_cvt_pk_bf16_f32 v108, v216, v217
    v_cvt_pk_bf16_f32 v109, v218, v219
    v_fma_f32 v224, v224, s42, -v34
    v_fma_f32 v225, v225, s42, -v34
    v_fma_f32 v226, v226, s42, -v34
    v_fma_f32 v227, v227, s42, -v34
    v_exp_f32 v224, v224
    v_exp_f32 v225, v225
    v_exp_f32 v226, v226
    v_exp_f32 v227, v227
    v_cvt_pk_bf16_f32 v110, v220, v221
    v_cvt_pk_bf16_f32 v111, v222, v223
    v_fma_f32 v228, v228, s42, -v34
    v_fma_f32 v229, v229, s42, -v34
    v_fma_f32 v230, v230, s42, -v34
    v_fma_f32 v231, v231, s42, -v34
    v_exp_f32 v228, v228
    v_exp_f32 v229, v229
    v_exp_f32 v230, v230
    v_exp_f32 v231, v231
    v_cvt_pk_bf16_f32 v112, v224, v225
    v_cvt_pk_bf16_f32 v113, v226, v227
    v_fma_f32 v232, v232, s42, -v35
    v_fma_f32 v233, v233, s42, -v35
    v_fma_f32 v234, v234, s42, -v35
    v_fma_f32 v235, v235, s42, -v35
    v_exp_f32 v232, v232
    v_exp_f32 v233, v233
    v_exp_f32 v234, v234
    v_exp_f32 v235, v235
    v_cvt_pk_bf16_f32 v114, v228, v229
    v_cvt_pk_bf16_f32 v115, v230, v231
    v_fma_f32 v236, v236, s42, -v35
    v_fma_f32 v237, v237, s42, -v35
    v_fma_f32 v238, v238, s42, -v35
    v_fma_f32 v239, v239, s42, -v35
    v_exp_f32 v236, v236
    v_exp_f32 v237, v237
    v_exp_f32 v238, v238
    v_exp_f32 v239, v239
    v_cvt_pk_bf16_f32 v116, v232, v233
    v_cvt_pk_bf16_f32 v117, v234, v235
    v_fma_f32 v240, v240, s42, -v34
    v_fma_f32 v241, v241, s42, -v34
    v_fma_f32 v242, v242, s42, -v34
    v_fma_f32 v243, v243, s42, -v34
    v_exp_f32 v240, v240
    v_exp_f32 v241, v241
    v_exp_f32 v242, v242
    v_exp_f32 v243, v243
    v_cvt_pk_bf16_f32 v118, v236, v237
    v_cvt_pk_bf16_f32 v119, v238, v239
    v_fma_f32 v244, v244, s42, -v34
    v_fma_f32 v245, v245, s42, -v34
    v_fma_f32 v246, v246, s42, -v34
    v_fma_f32 v247, v247, s42, -v34
    v_exp_f32 v244, v244
    v_exp_f32 v245, v245
    v_exp_f32 v246, v246
    v_exp_f32 v247, v247
    v_cvt_pk_bf16_f32 v120, v240, v241
    v_cvt_pk_bf16_f32 v121, v242, v243
    v_fma_f32 v248, v248, s42, -v35
    v_fma_f32 v249, v249, s42, -v35
    v_fma_f32 v250, v250, s42, -v35
    v_fma_f32 v251, v251, s42, -v35
    v_exp_f32 v248, v248
    v_exp_f32 v249, v249
    v_exp_f32 v250, v250
    v_exp_f32 v251, v251
    v_cvt_pk_bf16_f32 v122, v244, v245
    v_cvt_pk_bf16_f32 v123, v246, v247
    v_fma_f32 v252, v252, s42, -v35
    v_fma_f32 v253, v253, s42, -v35
    v_fma_f32 v254, v254, s42, -v35
    v_fma_f32 v255, v255, s42, -v35
    v_exp_f32 v252, v252
    v_exp_f32 v253, v253
    v_exp_f32 v254, v254
    v_exp_f32 v255, v255
    v_cvt_pk_bf16_f32 v124, v248, v249
    v_cvt_pk_bf16_f32 v125, v250, v251
    v_cvt_pk_bf16_f32 v126, v252, v253
    v_cvt_pk_bf16_f32 v127, v254, v255
    v_mov_b32 v28, 0x3f803f80
    v_mov_b32 v29, 0x3f803f80
    v_mov_b32 v30, 0x3f803f80
    v_mov_b32 v31, 0x3f803f80
    s_setprio 1
    s_barrier
    ds_read_b64_tr_b16 v[20:21], v16 offset:0
    ds_read_b64_tr_b16 v[22:23], v16 offset:2048
    ds_read_b64_tr_b16 v[36:37], v17 offset:0
    ds_read_b64_tr_b16 v[38:39], v17 offset:2048
    ds_read_b64_tr_b16 v[40:41], v18 offset:0
    ds_read_b64_tr_b16 v[42:43], v18 offset:2048
    ds_read_b64_tr_b16 v[44:45], v19 offset:0
    ds_read_b64_tr_b16 v[46:47], v19 offset:2048
    s_waitcnt lgkmcnt(4)
    v_mfma_f32_16x16x32_bf16 v[128:131], v[20:23], v[64:67], 0
    ds_read_b64_tr_b16 v[48:49], v16 offset:4096
    ds_read_b64_tr_b16 v[50:51], v16 offset:6144
    v_mfma_f32_16x16x32_bf16 v[136:139], v[20:23], v[68:71], 0
    s_add_u32 m0, s32, 0
    s_add_u32 s33, s4, 65536
    v_mfma_f32_16x16x32_bf16 v[132:135], v[36:39], v[64:67], 0
    ds_read_b64_tr_b16 v[52:53], v17 offset:4096
    ds_read_b64_tr_b16 v[54:55], v17 offset:6144
    v_mfma_f32_16x16x32_bf16 v[140:143], v[36:39], v[68:71], 0
    buffer_load_dwordx4 v3, s[24:27], s33 offen nt lds
    s_waitcnt lgkmcnt(4)
    v_mfma_f32_16x16x32_bf16 v[144:147], v[40:43], v[64:67], 0
    ds_read_b64_tr_b16 v[56:57], v18 offset:4096
    ds_read_b64_tr_b16 v[58:59], v18 offset:6144
    v_mfma_f32_16x16x32_bf16 v[152:155], v[40:43], v[68:71], 0
    v_mfma_f32_16x16x32_bf16 v[148:151], v[44:47], v[64:67], 0
    ds_read_b64_tr_b16 v[60:61], v19 offset:4096
    ds_read_b64_tr_b16 v[62:63], v19 offset:6144
    v_mfma_f32_16x16x32_bf16 v[156:159], v[44:47], v[68:71], 0
    s_waitcnt lgkmcnt(4)
    s_add_u32 m0, s32, 4096
    s_add_u32 s33, s4, 81920
    v_mfma_f32_16x16x32_bf16 v[128:131], v[48:51], v[72:75], v[128:131]
    ds_read_b64_tr_b16 v[20:21], v16 offset:8192
    ds_read_b64_tr_b16 v[22:23], v16 offset:10240
    v_mfma_f32_16x16x32_bf16 v[136:139], v[48:51], v[76:79], v[136:139]
    buffer_load_dwordx4 v3, s[24:27], s33 offen nt lds
    v_mfma_f32_16x16x32_bf16 v[132:135], v[52:55], v[72:75], v[132:135]
    ds_read_b64_tr_b16 v[36:37], v17 offset:8192
    ds_read_b64_tr_b16 v[38:39], v17 offset:10240
    v_mfma_f32_16x16x32_bf16 v[140:143], v[52:55], v[76:79], v[140:143]
    s_waitcnt lgkmcnt(4)
    v_mfma_f32_16x16x32_bf16 v[144:147], v[56:59], v[72:75], v[144:147]
    ds_read_b64_tr_b16 v[40:41], v18 offset:8192
    ds_read_b64_tr_b16 v[42:43], v18 offset:10240
    v_mfma_f32_16x16x32_bf16 v[152:155], v[56:59], v[76:79], v[152:155]
    s_add_u32 m0, s32, 8192
    s_add_u32 s33, s4, 98304
    v_mfma_f32_16x16x32_bf16 v[148:151], v[60:63], v[72:75], v[148:151]
    ds_read_b64_tr_b16 v[44:45], v19 offset:8192
    ds_read_b64_tr_b16 v[46:47], v19 offset:10240
    v_mfma_f32_16x16x32_bf16 v[156:159], v[60:63], v[76:79], v[156:159]
    buffer_load_dwordx4 v3, s[24:27], s33 offen nt lds
    s_waitcnt lgkmcnt(4)
    v_mfma_f32_16x16x32_bf16 v[128:131], v[20:23], v[80:83], v[128:131]
    ds_read_b64_tr_b16 v[48:49], v16 offset:12288
    ds_read_b64_tr_b16 v[50:51], v16 offset:14336
    v_mfma_f32_16x16x32_bf16 v[136:139], v[20:23], v[84:87], v[136:139]
    v_mfma_f32_16x16x32_bf16 v[132:135], v[36:39], v[80:83], v[132:135]
    ds_read_b64_tr_b16 v[52:53], v17 offset:12288
    ds_read_b64_tr_b16 v[54:55], v17 offset:14336
    v_mfma_f32_16x16x32_bf16 v[140:143], v[36:39], v[84:87], v[140:143]
    s_waitcnt lgkmcnt(4)
    s_add_u32 m0, s32, 12288
    s_add_u32 s33, s4, 114688
    v_mfma_f32_16x16x32_bf16 v[144:147], v[40:43], v[80:83], v[144:147]
    ds_read_b64_tr_b16 v[56:57], v18 offset:12288
    ds_read_b64_tr_b16 v[58:59], v18 offset:14336
    v_mfma_f32_16x16x32_bf16 v[152:155], v[40:43], v[84:87], v[152:155]
    buffer_load_dwordx4 v3, s[24:27], s33 offen nt lds
    v_mfma_f32_16x16x32_bf16 v[148:151], v[44:47], v[80:83], v[148:151]
    ds_read_b64_tr_b16 v[60:61], v19 offset:12288
    ds_read_b64_tr_b16 v[62:63], v19 offset:14336
    v_mfma_f32_16x16x32_bf16 v[156:159], v[44:47], v[84:87], v[156:159]
    s_waitcnt lgkmcnt(4)
    v_mfma_f32_16x16x32_bf16 v[128:131], v[48:51], v[88:91], v[128:131]
    v_mfma_f32_16x16x32_bf16 v[136:139], v[48:51], v[92:95], v[136:139]
    s_barrier
    ds_read_b64_tr_b16 v[20:21], v16 offset:16384
    ds_read_b64_tr_b16 v[22:23], v16 offset:18432
    v_mfma_f32_16x16x32_bf16 v[132:135], v[52:55], v[88:91], v[132:135]
    ds_read_b64_tr_b16 v[36:37], v17 offset:16384
    ds_read_b64_tr_b16 v[38:39], v17 offset:18432
    v_mfma_f32_16x16x32_bf16 v[140:143], v[52:55], v[92:95], v[140:143]
    s_waitcnt lgkmcnt(4)
    s_add_u32 m0, s32, 16384
    s_add_u32 s33, s5, 65536
    v_mfma_f32_16x16x32_bf16 v[144:147], v[56:59], v[88:91], v[144:147]
    ds_read_b64_tr_b16 v[40:41], v18 offset:16384
    ds_read_b64_tr_b16 v[42:43], v18 offset:18432
    v_mfma_f32_16x16x32_bf16 v[152:155], v[56:59], v[92:95], v[152:155]
    buffer_load_dwordx4 v3, s[24:27], s33 offen nt lds
    v_mfma_f32_16x16x32_bf16 v[148:151], v[60:63], v[88:91], v[148:151]
    ds_read_b64_tr_b16 v[44:45], v19 offset:16384
    ds_read_b64_tr_b16 v[46:47], v19 offset:18432
    v_mfma_f32_16x16x32_bf16 v[156:159], v[60:63], v[92:95], v[156:159]
    s_waitcnt lgkmcnt(4)
    v_mfma_f32_16x16x32_bf16 v[160:163], v[20:23], v[64:67], 0
    ds_read_b64_tr_b16 v[48:49], v16 offset:20480
    ds_read_b64_tr_b16 v[50:51], v16 offset:22528
    v_mfma_f32_16x16x32_bf16 v[168:171], v[20:23], v[68:71], 0
    s_add_u32 m0, s32, 20480
    s_add_u32 s33, s5, 81920
    v_mfma_f32_16x16x32_bf16 v[164:167], v[36:39], v[64:67], 0
    ds_read_b64_tr_b16 v[52:53], v17 offset:20480
    ds_read_b64_tr_b16 v[54:55], v17 offset:22528
    v_mfma_f32_16x16x32_bf16 v[172:175], v[36:39], v[68:71], 0
    buffer_load_dwordx4 v3, s[24:27], s33 offen nt lds
    s_waitcnt lgkmcnt(4)
    v_mfma_f32_16x16x32_bf16 v[176:179], v[40:43], v[64:67], 0
    ds_read_b64_tr_b16 v[56:57], v18 offset:20480
    ds_read_b64_tr_b16 v[58:59], v18 offset:22528
    v_mfma_f32_16x16x32_bf16 v[184:187], v[40:43], v[68:71], 0
    v_mfma_f32_16x16x32_bf16 v[180:183], v[44:47], v[64:67], 0
    ds_read_b64_tr_b16 v[60:61], v19 offset:20480
    ds_read_b64_tr_b16 v[62:63], v19 offset:22528
    v_mfma_f32_16x16x32_bf16 v[188:191], v[44:47], v[68:71], 0
    s_waitcnt lgkmcnt(4)
    s_add_u32 m0, s32, 24576
    s_add_u32 s33, s5, 98304
    v_mfma_f32_16x16x32_bf16 v[160:163], v[48:51], v[72:75], v[160:163]
    ds_read_b64_tr_b16 v[20:21], v16 offset:24576
    ds_read_b64_tr_b16 v[22:23], v16 offset:26624
    v_mfma_f32_16x16x32_bf16 v[168:171], v[48:51], v[76:79], v[168:171]
    buffer_load_dwordx4 v3, s[24:27], s33 offen nt lds
    v_mfma_f32_16x16x32_bf16 v[164:167], v[52:55], v[72:75], v[164:167]
    ds_read_b64_tr_b16 v[36:37], v17 offset:24576
    ds_read_b64_tr_b16 v[38:39], v17 offset:26624
    v_mfma_f32_16x16x32_bf16 v[172:175], v[52:55], v[76:79], v[172:175]
    s_waitcnt lgkmcnt(4)
    v_mfma_f32_16x16x32_bf16 v[176:179], v[56:59], v[72:75], v[176:179]
    ds_read_b64_tr_b16 v[40:41], v18 offset:24576
    ds_read_b64_tr_b16 v[42:43], v18 offset:26624
    v_mfma_f32_16x16x32_bf16 v[184:187], v[56:59], v[76:79], v[184:187]
    s_add_u32 m0, s32, 28672
    s_add_u32 s33, s5, 114688
    v_mfma_f32_16x16x32_bf16 v[180:183], v[60:63], v[72:75], v[180:183]
    ds_read_b64_tr_b16 v[44:45], v19 offset:24576
    ds_read_b64_tr_b16 v[46:47], v19 offset:26624
    v_mfma_f32_16x16x32_bf16 v[188:191], v[60:63], v[76:79], v[188:191]
    buffer_load_dwordx4 v3, s[24:27], s33 offen nt lds
    s_waitcnt lgkmcnt(4)
    v_mfma_f32_16x16x32_bf16 v[160:163], v[20:23], v[80:83], v[160:163]
    ds_read_b64_tr_b16 v[48:49], v16 offset:28672
    ds_read_b64_tr_b16 v[50:51], v16 offset:30720
    v_mfma_f32_16x16x32_bf16 v[168:171], v[20:23], v[84:87], v[168:171]
    v_mfma_f32_16x16x32_bf16 v[164:167], v[36:39], v[80:83], v[164:167]
    ds_read_b64_tr_b16 v[52:53], v17 offset:28672
    ds_read_b64_tr_b16 v[54:55], v17 offset:30720
    v_mfma_f32_16x16x32_bf16 v[172:175], v[36:39], v[84:87], v[172:175]
    s_waitcnt lgkmcnt(4)
    v_mfma_f32_16x16x32_bf16 v[176:179], v[40:43], v[80:83], v[176:179]
    ds_read_b64_tr_b16 v[56:57], v18 offset:28672
    ds_read_b64_tr_b16 v[58:59], v18 offset:30720
    v_mfma_f32_16x16x32_bf16 v[184:187], v[40:43], v[84:87], v[184:187]
    v_mfma_f32_16x16x32_bf16 v[180:183], v[44:47], v[80:83], v[180:183]
    ds_read_b64_tr_b16 v[60:61], v19 offset:28672
    ds_read_b64_tr_b16 v[62:63], v19 offset:30720
    v_mfma_f32_16x16x32_bf16 v[188:191], v[44:47], v[84:87], v[188:191]
    s_waitcnt lgkmcnt(4)
    v_mfma_f32_16x16x32_bf16 v[160:163], v[48:51], v[88:91], v[160:163]
    v_mfma_f32_16x16x32_bf16 v[168:171], v[48:51], v[92:95], v[168:171]
    s_barrier
    ds_read_b64_tr_b16 v[20:21], v16 offset:32768
    ds_read_b64_tr_b16 v[22:23], v16 offset:34816
    v_mfma_f32_16x16x32_bf16 v[164:167], v[52:55], v[88:91], v[164:167]
    ds_read_b64_tr_b16 v[36:37], v17 offset:32768
    ds_read_b64_tr_b16 v[38:39], v17 offset:34816
    v_mfma_f32_16x16x32_bf16 v[172:175], v[52:55], v[92:95], v[172:175]
    ds_read_b64_tr_b16 v[40:41], v18 offset:32768
    ds_read_b64_tr_b16 v[42:43], v18 offset:34816
    ds_read_b32 v27, v25 offset:25600
    s_waitcnt lgkmcnt(7)
    v_mfma_f32_16x16x32_bf16 v[176:179], v[56:59], v[88:91], v[176:179]
    ds_read_b64_tr_b16 v[44:45], v19 offset:32768
    ds_read_b64_tr_b16 v[46:47], v19 offset:34816
    v_mfma_f32_16x16x32_bf16 v[184:187], v[56:59], v[92:95], v[184:187]
    s_add_u32 m0, s32, 32768
    s_add_u32 s33, s6, 65536
    v_mfma_f32_16x16x32_bf16 v[180:183], v[60:63], v[88:91], v[180:183]
    ds_read_b64_tr_b16 v[48:49], v16 offset:36864
    ds_read_b64_tr_b16 v[50:51], v16 offset:38912
    v_mfma_f32_16x16x32_bf16 v[188:191], v[60:63], v[92:95], v[188:191]
    buffer_load_dwordx4 v3, s[24:27], s33 offen nt lds
    s_waitcnt lgkmcnt(7)
    v_mfma_f32_16x16x32_bf16 v[192:195], v[20:23], v[64:67], 0
    ds_read_b64_tr_b16 v[52:53], v17 offset:36864
    ds_read_b64_tr_b16 v[54:55], v17 offset:38912
    v_mfma_f32_16x16x32_bf16 v[200:203], v[20:23], v[68:71], 0
    s_add_u32 m0, s32, 36864
    s_add_u32 s33, s6, 81920
    v_mfma_f32_16x16x32_bf16 v[196:199], v[36:39], v[64:67], 0
    ds_read_b64_tr_b16 v[56:57], v18 offset:36864
    ds_read_b64_tr_b16 v[58:59], v18 offset:38912
    v_mfma_f32_16x16x32_bf16 v[204:207], v[36:39], v[68:71], 0
    ds_read_b64_tr_b16 v[60:61], v19 offset:36864
    ds_read_b64_tr_b16 v[62:63], v19 offset:38912
    s_waitcnt lgkmcnt(8)
    v_mfma_f32_16x16x32_bf16 v[208:211], v[40:43], v[64:67], 0
    ds_read_b64_tr_b16 v[20:21], v16 offset:40960
    ds_read_b64_tr_b16 v[22:23], v16 offset:43008
    v_mfma_f32_16x16x32_bf16 v[216:219], v[40:43], v[68:71], 0
    buffer_load_dwordx4 v3, s[24:27], s33 offen nt lds
    v_mfma_f32_16x16x32_bf16 v[212:215], v[44:47], v[64:67], 0
    ds_read_b64_tr_b16 v[36:37], v17 offset:40960
    ds_read_b64_tr_b16 v[38:39], v17 offset:43008
    v_mfma_f32_16x16x32_bf16 v[220:223], v[44:47], v[68:71], 0
    s_waitcnt lgkmcnt(8)
    v_sub_f32 v27, v26, v27
    v_mfma_f32_16x16x32_bf16 v[192:195], v[48:51], v[72:75], v[192:195]
    ds_read_b64_tr_b16 v[40:41], v18 offset:40960
    ds_read_b64_tr_b16 v[42:43], v18 offset:43008
    v_mfma_f32_16x16x32_bf16 v[200:203], v[48:51], v[76:79], v[200:203]
    v_exp_f32 v27, v27
    s_nop 0
    v_cmp_neq_f32 s[44:45], 1.0, v27
    v_mfma_f32_16x16x32_bf16 v[196:199], v[52:55], v[72:75], v[196:199]
    ds_read_b64_tr_b16 v[44:45], v19 offset:40960
    ds_read_b64_tr_b16 v[46:47], v19 offset:43008
    v_mfma_f32_16x16x32_bf16 v[204:207], v[52:55], v[76:79], v[204:207]
    ds_read_b64_tr_b16 v[48:49], v16 offset:45056
    ds_read_b64_tr_b16 v[50:51], v16 offset:47104
    s_waitcnt lgkmcnt(10)
    v_mfma_f32_16x16x32_bf16 v[208:211], v[56:59], v[72:75], v[208:211]
    ds_read_b64_tr_b16 v[52:53], v17 offset:45056
    ds_read_b64_tr_b16 v[54:55], v17 offset:47104
    v_mfma_f32_16x16x32_bf16 v[216:219], v[56:59], v[76:79], v[216:219]
    s_add_u32 m0, s32, 40960
    s_add_u32 s33, s6, 98304
    v_mfma_f32_16x16x32_bf16 v[212:215], v[60:63], v[72:75], v[212:215]
    ds_read_b64_tr_b16 v[56:57], v18 offset:45056
    ds_read_b64_tr_b16 v[58:59], v18 offset:47104
    v_mfma_f32_16x16x32_bf16 v[220:223], v[60:63], v[76:79], v[220:223]
    buffer_load_dwordx4 v3, s[24:27], s33 offen nt lds
    s_waitcnt lgkmcnt(10)
    v_mfma_f32_16x16x32_bf16 v[192:195], v[20:23], v[80:83], v[192:195]
    ds_read_b64_tr_b16 v[60:61], v19 offset:45056
    ds_read_b64_tr_b16 v[62:63], v19 offset:47104
    v_mfma_f32_16x16x32_bf16 v[200:203], v[20:23], v[84:87], v[200:203]
    s_add_u32 m0, s32, 45056
    s_add_u32 s33, s6, 114688
    v_mfma_f32_16x16x32_bf16 v[196:199], v[36:39], v[80:83], v[196:199]
    v_mfma_f32_16x16x32_bf16 v[204:207], v[36:39], v[84:87], v[204:207]
    buffer_load_dwordx4 v3, s[24:27], s33 offen nt lds
    s_barrier
    s_waitcnt lgkmcnt(8)
    v_mfma_f32_16x16x32_bf16 v[208:211], v[40:43], v[80:83], v[208:211]
    v_mfma_f32_16x16x32_bf16 v[216:219], v[40:43], v[84:87], v[216:219]
    v_mfma_f32_16x16x32_bf16 v[4:7], v[28:31], v[64:67], 0
    v_mfma_f32_16x16x32_bf16 v[8:11], v[28:31], v[68:71], 0
    v_mfma_f32_16x16x32_bf16 v[4:7], v[28:31], v[72:75], v[4:7]
    v_mfma_f32_16x16x32_bf16 v[8:11], v[28:31], v[76:79], v[8:11]
    v_mfma_f32_16x16x32_bf16 v[212:215], v[44:47], v[80:83], v[212:215]
    v_mfma_f32_16x16x32_bf16 v[220:223], v[44:47], v[84:87], v[220:223]
    s_waitcnt lgkmcnt(4)
    v_mfma_f32_16x16x32_bf16 v[192:195], v[48:51], v[88:91], v[192:195]
    ds_read_b64_tr_b16 v[20:21], v16 offset:49152
    ds_read_b64_tr_b16 v[22:23], v16 offset:51200
    v_mfma_f32_16x16x32_bf16 v[200:203], v[48:51], v[92:95], v[200:203]
    v_mfma_f32_16x16x32_bf16 v[196:199], v[52:55], v[88:91], v[196:199]
    ds_read_b64_tr_b16 v[36:37], v17 offset:49152
    ds_read_b64_tr_b16 v[38:39], v17 offset:51200
    v_mfma_f32_16x16x32_bf16 v[204:207], v[52:55], v[92:95], v[204:207]
    ds_read_b64_tr_b16 v[40:41], v18 offset:49152
    ds_read_b64_tr_b16 v[42:43], v18 offset:51200
    s_waitcnt lgkmcnt(6)
    v_mfma_f32_16x16x32_bf16 v[208:211], v[56:59], v[88:91], v[208:211]
    ds_read_b64_tr_b16 v[44:45], v19 offset:49152
    ds_read_b64_tr_b16 v[46:47], v19 offset:51200
    v_mfma_f32_16x16x32_bf16 v[216:219], v[56:59], v[92:95], v[216:219]
    s_add_u32 m0, s32, 49152
    s_add_u32 s33, s7, 65536
    v_mfma_f32_16x16x32_bf16 v[212:215], v[60:63], v[88:91], v[212:215]
    ds_read_b64_tr_b16 v[48:49], v16 offset:53248
    ds_read_b64_tr_b16 v[50:51], v16 offset:55296
    v_mfma_f32_16x16x32_bf16 v[220:223], v[60:63], v[92:95], v[220:223]
    buffer_load_dwordx4 v3, s[24:27], s33 offen nt lds
    s_waitcnt lgkmcnt(6)
    v_mfma_f32_16x16x32_bf16 v[224:227], v[20:23], v[64:67], 0
    ds_read_b64_tr_b16 v[52:53], v17 offset:53248
    ds_read_b64_tr_b16 v[54:55], v17 offset:55296
    v_mfma_f32_16x16x32_bf16 v[232:235], v[20:23], v[68:71], 0
    s_add_u32 m0, s32, 53248
    s_add_u32 s33, s7, 81920
    v_mfma_f32_16x16x32_bf16 v[228:231], v[36:39], v[64:67], 0
    ds_read_b64_tr_b16 v[56:57], v18 offset:53248
    ds_read_b64_tr_b16 v[58:59], v18 offset:55296
    v_mfma_f32_16x16x32_bf16 v[236:239], v[36:39], v[68:71], 0
    ds_read_b64_tr_b16 v[60:61], v19 offset:53248
    ds_read_b64_tr_b16 v[62:63], v19 offset:55296
    s_waitcnt lgkmcnt(8)
    v_mfma_f32_16x16x32_bf16 v[240:243], v[40:43], v[64:67], 0
    ds_read_b64_tr_b16 v[20:21], v16 offset:57344
    ds_read_b64_tr_b16 v[22:23], v16 offset:59392
    v_mfma_f32_16x16x32_bf16 v[248:251], v[40:43], v[68:71], 0
    buffer_load_dwordx4 v3, s[24:27], s33 offen nt lds
    v_mfma_f32_16x16x32_bf16 v[244:247], v[44:47], v[64:67], 0
    ds_read_b64_tr_b16 v[36:37], v17 offset:57344
    ds_read_b64_tr_b16 v[38:39], v17 offset:59392
    v_mfma_f32_16x16x32_bf16 v[252:255], v[44:47], v[68:71], 0
    s_waitcnt lgkmcnt(8)
    s_add_u32 m0, s32, 57344
    s_add_u32 s33, s7, 98304
    v_mfma_f32_16x16x32_bf16 v[224:227], v[48:51], v[72:75], v[224:227]
    ds_read_b64_tr_b16 v[40:41], v18 offset:57344
    ds_read_b64_tr_b16 v[42:43], v18 offset:59392
    v_mfma_f32_16x16x32_bf16 v[232:235], v[48:51], v[76:79], v[232:235]
    buffer_load_dwordx4 v3, s[24:27], s33 offen nt lds
    v_mfma_f32_16x16x32_bf16 v[228:231], v[52:55], v[72:75], v[228:231]
    ds_read_b64_tr_b16 v[44:45], v19 offset:57344
    ds_read_b64_tr_b16 v[46:47], v19 offset:59392
    v_mfma_f32_16x16x32_bf16 v[236:239], v[52:55], v[76:79], v[236:239]
    ds_read_b64_tr_b16 v[48:49], v16 offset:61440
    ds_read_b64_tr_b16 v[50:51], v16 offset:63488
    s_waitcnt lgkmcnt(10)
    v_mfma_f32_16x16x32_bf16 v[240:243], v[56:59], v[72:75], v[240:243]
    ds_read_b64_tr_b16 v[52:53], v17 offset:61440
    ds_read_b64_tr_b16 v[54:55], v17 offset:63488
    v_mfma_f32_16x16x32_bf16 v[248:251], v[56:59], v[76:79], v[248:251]
    s_add_u32 m0, s32, 61440
    s_add_u32 s33, s7, 114688
    v_mfma_f32_16x16x32_bf16 v[244:247], v[60:63], v[72:75], v[244:247]
    ds_read_b64_tr_b16 v[56:57], v18 offset:61440
    ds_read_b64_tr_b16 v[58:59], v18 offset:63488
    v_mfma_f32_16x16x32_bf16 v[252:255], v[60:63], v[76:79], v[252:255]
    buffer_load_dwordx4 v3, s[24:27], s33 offen nt lds
    s_waitcnt lgkmcnt(10)
    v_mfma_f32_16x16x32_bf16 v[224:227], v[20:23], v[80:83], v[224:227]
    ds_read_b64_tr_b16 v[60:61], v19 offset:61440
    ds_read_b64_tr_b16 v[62:63], v19 offset:63488
    v_mfma_f32_16x16x32_bf16 v[232:235], v[20:23], v[84:87], v[232:235]
    v_mfma_f32_16x16x32_bf16 v[228:231], v[36:39], v[80:83], v[228:231]
    v_mfma_f32_16x16x32_bf16 v[236:239], v[36:39], v[84:87], v[236:239]
    s_waitcnt vmcnt(12)
    s_barrier
    s_waitcnt lgkmcnt(8)
    v_mfma_f32_16x16x32_bf16 v[240:243], v[40:43], v[80:83], v[240:243]
    v_mfma_f32_16x16x32_bf16 v[248:251], v[40:43], v[84:87], v[248:251]
    v_mfma_f32_16x16x32_bf16 v[4:7], v[28:31], v[80:83], v[4:7]
    v_mfma_f32_16x16x32_bf16 v[8:11], v[28:31], v[84:87], v[8:11]
    v_mfma_f32_16x16x32_bf16 v[4:7], v[28:31], v[88:91], v[4:7]
    v_mfma_f32_16x16x32_bf16 v[8:11], v[28:31], v[92:95], v[8:11]
    v_mfma_f32_16x16x32_bf16 v[244:247], v[44:47], v[80:83], v[244:247]
    v_mfma_f32_16x16x32_bf16 v[252:255], v[44:47], v[84:87], v[252:255]
    s_waitcnt lgkmcnt(4)
    v_mfma_f32_16x16x32_bf16 v[224:227], v[48:51], v[88:91], v[224:227]
    ds_read_b64_tr_b16 v[20:21], v12 offset:0
    ds_read_b64_tr_b16 v[22:23], v12 offset:2048
    v_mfma_f32_16x16x32_bf16 v[232:235], v[48:51], v[92:95], v[232:235]
    v_mfma_f32_16x16x32_bf16 v[228:231], v[52:55], v[88:91], v[228:231]
    ds_read_b64_tr_b16 v[36:37], v13 offset:0
    ds_read_b64_tr_b16 v[38:39], v13 offset:2048
    v_mfma_f32_16x16x32_bf16 v[236:239], v[52:55], v[92:95], v[236:239]
    ds_read_b64_tr_b16 v[40:41], v14 offset:0
    ds_read_b64_tr_b16 v[42:43], v14 offset:2048
    ds_read_b128 v[64:67], v25 offset:0
    s_waitcnt lgkmcnt(7)
    v_mfma_f32_16x16x32_bf16 v[240:243], v[56:59], v[88:91], v[240:243]
    ds_read_b64_tr_b16 v[44:45], v15 offset:0
    ds_read_b64_tr_b16 v[46:47], v15 offset:2048
    v_mfma_f32_16x16x32_bf16 v[248:251], v[56:59], v[92:95], v[248:251]
    ds_read_b128 v[68:71], v25 offset:1024
    s_add_u32 m0, s32, 65536
    v_mfma_f32_16x16x32_bf16 v[244:247], v[60:63], v[88:91], v[244:247]
    ds_read_b64_tr_b16 v[48:49], v12 offset:4096
    ds_read_b64_tr_b16 v[50:51], v12 offset:6144
    v_mfma_f32_16x16x32_bf16 v[252:255], v[60:63], v[92:95], v[252:255]
    s_waitcnt lgkmcnt(8)
    s_add_u32 s33, s4, 131072
    v_mfma_f32_16x16x32_bf16 v[128:131], v[20:23], v[96:99], v[128:131]
    ds_read_b64_tr_b16 v[52:53], v13 offset:4096
    ds_read_b64_tr_b16 v[54:55], v13 offset:6144
    v_mfma_f32_16x16x32_bf16 v[136:139], v[20:23], v[100:103], v[136:139]
    buffer_load_dwordx4 v3, s[24:27], s33 offen nt lds
    v_mfma_f32_16x16x32_bf16 v[132:135], v[36:39], v[96:99], v[132:135]
    ds_read_b64_tr_b16 v[56:57], v14 offset:4096
    ds_read_b64_tr_b16 v[58:59], v14 offset:6144
    v_mfma_f32_16x16x32_bf16 v[140:143], v[36:39], v[100:103], v[140:143]
    ds_read_b64_tr_b16 v[60:61], v15 offset:4096
    ds_read_b64_tr_b16 v[62:63], v15 offset:6144
    s_waitcnt lgkmcnt(9)
    v_mfma_f32_16x16x32_bf16 v[144:147], v[40:43], v[96:99], v[144:147]
    ds_read_b64_tr_b16 v[20:21], v12 offset:8192
    ds_read_b64_tr_b16 v[22:23], v12 offset:10240
    v_mfma_f32_16x16x32_bf16 v[152:155], v[40:43], v[100:103], v[152:155]
    s_add_u32 m0, s32, 69632
    s_add_u32 s33, s4, 147456
    v_mfma_f32_16x16x32_bf16 v[148:151], v[44:47], v[96:99], v[148:151]
    ds_read_b64_tr_b16 v[36:37], v13 offset:8192
    ds_read_b64_tr_b16 v[38:39], v13 offset:10240
    v_mfma_f32_16x16x32_bf16 v[156:159], v[44:47], v[100:103], v[156:159]
    buffer_load_dwordx4 v3, s[24:27], s33 offen nt lds
    s_waitcnt lgkmcnt(8)
    v_mfma_f32_16x16x32_bf16 v[128:131], v[48:51], v[104:107], v[128:131]
    ds_read_b64_tr_b16 v[40:41], v14 offset:8192
    ds_read_b64_tr_b16 v[42:43], v14 offset:10240
    v_mfma_f32_16x16x32_bf16 v[136:139], v[48:51], v[108:111], v[136:139]
    s_add_u32 m0, s32, 73728
    s_add_u32 s33, s4, 163840
    v_mfma_f32_16x16x32_bf16 v[132:135], v[52:55], v[104:107], v[132:135]
    ds_read_b64_tr_b16 v[44:45], v15 offset:8192
    ds_read_b64_tr_b16 v[46:47], v15 offset:10240
    v_mfma_f32_16x16x32_bf16 v[140:143], v[52:55], v[108:111], v[140:143]
    ds_read_b64_tr_b16 v[48:49], v12 offset:12288
    ds_read_b64_tr_b16 v[50:51], v12 offset:14336
    s_waitcnt lgkmcnt(10)
    v_mfma_f32_16x16x32_bf16 v[144:147], v[56:59], v[104:107], v[144:147]
    ds_read_b64_tr_b16 v[52:53], v13 offset:12288
    ds_read_b64_tr_b16 v[54:55], v13 offset:14336
    v_mfma_f32_16x16x32_bf16 v[152:155], v[56:59], v[108:111], v[152:155]
    buffer_load_dwordx4 v3, s[24:27], s33 offen nt lds
    v_mfma_f32_16x16x32_bf16 v[148:151], v[60:63], v[104:107], v[148:151]
    ds_read_b64_tr_b16 v[56:57], v14 offset:12288
    ds_read_b64_tr_b16 v[58:59], v14 offset:14336
    v_mfma_f32_16x16x32_bf16 v[156:159], v[60:63], v[108:111], v[156:159]
    s_waitcnt lgkmcnt(10)
    s_add_u32 m0, s32, 77824
    s_add_u32 s33, s4, 180224
    v_mfma_f32_16x16x32_bf16 v[128:131], v[20:23], v[112:115], v[128:131]
    ds_read_b64_tr_b16 v[60:61], v15 offset:12288
    ds_read_b64_tr_b16 v[62:63], v15 offset:14336
    v_mfma_f32_16x16x32_bf16 v[136:139], v[20:23], v[116:119], v[136:139]
    buffer_load_dwordx4 v3, s[24:27], s33 offen nt lds
    v_mfma_f32_16x16x32_bf16 v[132:135], v[36:39], v[112:115], v[132:135]
    v_mfma_f32_16x16x32_bf16 v[140:143], v[36:39], v[116:119], v[140:143]
    s_waitcnt vmcnt(12)
    s_barrier
    s_waitcnt lgkmcnt(8)
    v_mfma_f32_16x16x32_bf16 v[144:147], v[40:43], v[112:115], v[144:147]
    v_mfma_f32_16x16x32_bf16 v[152:155], v[40:43], v[116:119], v[152:155]
    v_mfma_f32_16x16x32_bf16 v[4:7], v[28:31], v[96:99], v[4:7]
    v_mfma_f32_16x16x32_bf16 v[8:11], v[28:31], v[100:103], v[8:11]
    v_mfma_f32_16x16x32_bf16 v[4:7], v[28:31], v[104:107], v[4:7]
    v_mfma_f32_16x16x32_bf16 v[8:11], v[28:31], v[108:111], v[8:11]
    v_mfma_f32_16x16x32_bf16 v[148:151], v[44:47], v[112:115], v[148:151]
    v_mfma_f32_16x16x32_bf16 v[156:159], v[44:47], v[116:119], v[156:159]
    s_waitcnt lgkmcnt(4)
    v_mfma_f32_16x16x32_bf16 v[128:131], v[48:51], v[120:123], v[128:131]
    ds_read_b64_tr_b16 v[20:21], v12 offset:16384
    ds_read_b64_tr_b16 v[22:23], v12 offset:18432
    v_mfma_f32_16x16x32_bf16 v[136:139], v[48:51], v[124:127], v[136:139]
    v_mfma_f32_16x16x32_bf16 v[132:135], v[52:55], v[120:123], v[132:135]
    ds_read_b64_tr_b16 v[36:37], v13 offset:16384
    ds_read_b64_tr_b16 v[38:39], v13 offset:18432
    v_mfma_f32_16x16x32_bf16 v[140:143], v[52:55], v[124:127], v[140:143]
    ds_read_b64_tr_b16 v[40:41], v14 offset:16384
    ds_read_b64_tr_b16 v[42:43], v14 offset:18432
    ds_read_b128 v[72:75], v25 offset:8192
    s_waitcnt lgkmcnt(7)
    v_mfma_f32_16x16x32_bf16 v[144:147], v[56:59], v[120:123], v[144:147]
    ds_read_b64_tr_b16 v[44:45], v15 offset:16384
    ds_read_b64_tr_b16 v[46:47], v15 offset:18432
    v_mfma_f32_16x16x32_bf16 v[152:155], v[56:59], v[124:127], v[152:155]
    ds_read_b128 v[76:79], v25 offset:9216
    s_add_u32 m0, s32, 81920
    v_mfma_f32_16x16x32_bf16 v[148:151], v[60:63], v[120:123], v[148:151]
    ds_read_b64_tr_b16 v[48:49], v12 offset:20480
    ds_read_b64_tr_b16 v[50:51], v12 offset:22528
    v_mfma_f32_16x16x32_bf16 v[156:159], v[60:63], v[124:127], v[156:159]
    s_waitcnt lgkmcnt(8)
    s_add_u32 s33, s4, 196608
    v_mfma_f32_16x16x32_bf16 v[160:163], v[20:23], v[96:99], v[160:163]
    ds_read_b64_tr_b16 v[52:53], v13 offset:20480
    ds_read_b64_tr_b16 v[54:55], v13 offset:22528
    v_mfma_f32_16x16x32_bf16 v[168:171], v[20:23], v[100:103], v[168:171]
    buffer_load_dwordx4 v3, s[24:27], s33 offen nt lds
    v_mfma_f32_16x16x32_bf16 v[164:167], v[36:39], v[96:99], v[164:167]
    ds_read_b64_tr_b16 v[56:57], v14 offset:20480
    ds_read_b64_tr_b16 v[58:59], v14 offset:22528
    v_mfma_f32_16x16x32_bf16 v[172:175], v[36:39], v[100:103], v[172:175]
    ds_read_b64_tr_b16 v[60:61], v15 offset:20480
    ds_read_b64_tr_b16 v[62:63], v15 offset:22528
    s_waitcnt lgkmcnt(9)
    v_mfma_f32_16x16x32_bf16 v[176:179], v[40:43], v[96:99], v[176:179]
    ds_read_b64_tr_b16 v[20:21], v12 offset:24576
    ds_read_b64_tr_b16 v[22:23], v12 offset:26624
    v_mfma_f32_16x16x32_bf16 v[184:187], v[40:43], v[100:103], v[184:187]
    s_add_u32 m0, s32, 86016
    s_add_u32 s33, s4, 212992
    v_mfma_f32_16x16x32_bf16 v[180:183], v[44:47], v[96:99], v[180:183]
    ds_read_b64_tr_b16 v[36:37], v13 offset:24576
    ds_read_b64_tr_b16 v[38:39], v13 offset:26624
    v_mfma_f32_16x16x32_bf16 v[188:191], v[44:47], v[100:103], v[188:191]
    buffer_load_dwordx4 v3, s[24:27], s33 offen nt lds
    s_waitcnt lgkmcnt(8)
    v_mfma_f32_16x16x32_bf16 v[160:163], v[48:51], v[104:107], v[160:163]
    ds_read_b64_tr_b16 v[40:41], v14 offset:24576
    ds_read_b64_tr_b16 v[42:43], v14 offset:26624
    v_mfma_f32_16x16x32_bf16 v[168:171], v[48:51], v[108:111], v[168:171]
    s_add_u32 m0, s32, 90112
    s_add_u32 s33, s4, 229376
    v_mfma_f32_16x16x32_bf16 v[164:167], v[52:55], v[104:107], v[164:167]
    ds_read_b64_tr_b16 v[44:45], v15 offset:24576
    ds_read_b64_tr_b16 v[46:47], v15 offset:26624
    v_mfma_f32_16x16x32_bf16 v[172:175], v[52:55], v[108:111], v[172:175]
    ds_read_b64_tr_b16 v[48:49], v12 offset:28672
    ds_read_b64_tr_b16 v[50:51], v12 offset:30720
    s_waitcnt lgkmcnt(10)
    v_mfma_f32_16x16x32_bf16 v[176:179], v[56:59], v[104:107], v[176:179]
    ds_read_b64_tr_b16 v[52:53], v13 offset:28672
    ds_read_b64_tr_b16 v[54:55], v13 offset:30720
    v_mfma_f32_16x16x32_bf16 v[184:187], v[56:59], v[108:111], v[184:187]
    buffer_load_dwordx4 v3, s[24:27], s33 offen nt lds
    v_mfma_f32_16x16x32_bf16 v[180:183], v[60:63], v[104:107], v[180:183]
    ds_read_b64_tr_b16 v[56:57], v14 offset:28672
    ds_read_b64_tr_b16 v[58:59], v14 offset:30720
    v_mfma_f32_16x16x32_bf16 v[188:191], v[60:63], v[108:111], v[188:191]
    s_waitcnt lgkmcnt(10)
    s_add_u32 m0, s32, 94208
    s_add_u32 s33, s4, 245760
    v_mfma_f32_16x16x32_bf16 v[160:163], v[20:23], v[112:115], v[160:163]
    ds_read_b64_tr_b16 v[60:61], v15 offset:28672
    ds_read_b64_tr_b16 v[62:63], v15 offset:30720
    v_mfma_f32_16x16x32_bf16 v[168:171], v[20:23], v[116:119], v[168:171]
    buffer_load_dwordx4 v3, s[24:27], s33 offen nt lds
    v_mfma_f32_16x16x32_bf16 v[164:167], v[36:39], v[112:115], v[164:167]
    v_mfma_f32_16x16x32_bf16 v[172:175], v[36:39], v[116:119], v[172:175]
    s_waitcnt vmcnt(12)
    s_barrier
    s_waitcnt lgkmcnt(8)
    v_mfma_f32_16x16x32_bf16 v[176:179], v[40:43], v[112:115], v[176:179]
    v_mfma_f32_16x16x32_bf16 v[184:187], v[40:43], v[116:119], v[184:187]
    v_mfma_f32_16x16x32_bf16 v[4:7], v[28:31], v[112:115], v[4:7]
    v_mfma_f32_16x16x32_bf16 v[8:11], v[28:31], v[116:119], v[8:11]
    v_mfma_f32_16x16x32_bf16 v[4:7], v[28:31], v[120:123], v[4:7]
    v_mfma_f32_16x16x32_bf16 v[8:11], v[28:31], v[124:127], v[8:11]
    v_mfma_f32_16x16x32_bf16 v[180:183], v[44:47], v[112:115], v[180:183]
    v_mfma_f32_16x16x32_bf16 v[188:191], v[44:47], v[116:119], v[188:191]
    s_waitcnt lgkmcnt(4)
    v_mfma_f32_16x16x32_bf16 v[160:163], v[48:51], v[120:123], v[160:163]
    ds_read_b64_tr_b16 v[20:21], v12 offset:32768
    ds_read_b64_tr_b16 v[22:23], v12 offset:34816
    v_mfma_f32_16x16x32_bf16 v[168:171], v[48:51], v[124:127], v[168:171]
    v_mfma_f32_16x16x32_bf16 v[164:167], v[52:55], v[120:123], v[164:167]
    ds_read_b64_tr_b16 v[36:37], v13 offset:32768
    ds_read_b64_tr_b16 v[38:39], v13 offset:34816
    v_mfma_f32_16x16x32_bf16 v[172:175], v[52:55], v[124:127], v[172:175]
    ds_read_b64_tr_b16 v[40:41], v14 offset:32768
    ds_read_b64_tr_b16 v[42:43], v14 offset:34816
    ds_read_b128 v[80:83], v25 offset:16384
    s_waitcnt lgkmcnt(7)
    v_mfma_f32_16x16x32_bf16 v[176:179], v[56:59], v[120:123], v[176:179]
    ds_read_b64_tr_b16 v[44:45], v15 offset:32768
    ds_read_b64_tr_b16 v[46:47], v15 offset:34816
    v_mfma_f32_16x16x32_bf16 v[184:187], v[56:59], v[124:127], v[184:187]
    ds_read_b128 v[84:87], v25 offset:17408
    s_add_u32 m0, s32, 98304
    v_mfma_f32_16x16x32_bf16 v[180:183], v[60:63], v[120:123], v[180:183]
    ds_read_b64_tr_b16 v[48:49], v12 offset:36864
    ds_read_b64_tr_b16 v[50:51], v12 offset:38912
    v_mfma_f32_16x16x32_bf16 v[188:191], v[60:63], v[124:127], v[188:191]
    ds_read_b128 v[88:91], v25 offset:24576
    s_waitcnt lgkmcnt(9)
    s_add_u32 s33, s5, 131072
    v_mfma_f32_16x16x32_bf16 v[192:195], v[20:23], v[96:99], v[192:195]
    ds_read_b64_tr_b16 v[52:53], v13 offset:36864
    ds_read_b64_tr_b16 v[54:55], v13 offset:38912
    v_mfma_f32_16x16x32_bf16 v[200:203], v[20:23], v[100:103], v[200:203]
    ds_read_b128 v[92:95], v25 offset:25600
    v_mov_b32 v34, v27
    v_mov_b32 v35, v27
    v_mfma_f32_16x16x32_bf16 v[196:199], v[36:39], v[96:99], v[196:199]
    ds_read_b64_tr_b16 v[56:57], v14 offset:36864
    ds_read_b64_tr_b16 v[58:59], v14 offset:38912
    v_mfma_f32_16x16x32_bf16 v[204:207], v[36:39], v[100:103], v[204:207]
    ds_read_b64_tr_b16 v[60:61], v15 offset:36864
    s_waitcnt lgkmcnt(13)
    ds_read_b64_tr_b16 v[62:63], v15 offset:38912
    s_waitcnt lgkmcnt(11)
    v_permlane16_swap_b32 v34, v35
    s_nop 0
    v_mfma_f32_16x16x32_bf16 v[208:211], v[40:43], v[96:99], v[208:211]
    ds_read_b64_tr_b16 v[20:21], v12 offset:40960
    ds_read_b64_tr_b16 v[22:23], v12 offset:43008
    v_mfma_f32_16x16x32_bf16 v[216:219], v[40:43], v[100:103], v[216:219]
    buffer_load_dwordx4 v3, s[24:27], s33 offen nt lds
    v_mul_f32 v4, v34, v4
    v_mul_f32 v8, v35, v8
    v_mfma_f32_16x16x32_bf16 v[212:215], v[44:47], v[96:99], v[212:215]
    ds_read_b64_tr_b16 v[36:37], v13 offset:40960
    ds_read_b64_tr_b16 v[38:39], v13 offset:43008
    v_mfma_f32_16x16x32_bf16 v[220:223], v[44:47], v[100:103], v[220:223]
    s_waitcnt lgkmcnt(9)
    s_add_u32 m0, s32, 102400
    s_add_u32 s33, s5, 147456
    v_mfma_f32_16x16x32_bf16 v[192:195], v[48:51], v[104:107], v[192:195]
    ds_read_b64_tr_b16 v[40:41], v14 offset:40960
    ds_read_b64_tr_b16 v[42:43], v14 offset:43008
    v_mfma_f32_16x16x32_bf16 v[200:203], v[48:51], v[108:111], v[200:203]
    buffer_load_dwordx4 v3, s[24:27], s33 offen nt lds
    v_mfma_f32_16x16x32_bf16 v[196:199], v[52:55], v[104:107], v[196:199]
    ds_read_b64_tr_b16 v[44:45], v15 offset:40960
    ds_read_b64_tr_b16 v[46:47], v15 offset:43008
    v_mfma_f32_16x16x32_bf16 v[204:207], v[52:55], v[108:111], v[204:207]
    ds_read_b64_tr_b16 v[48:49], v12 offset:45056
    ds_read_b64_tr_b16 v[50:51], v12 offset:47104
    s_waitcnt lgkmcnt(10)
    v_mfma_f32_16x16x32_bf16 v[208:211], v[56:59], v[104:107], v[208:211]
    ds_read_b64_tr_b16 v[52:53], v13 offset:45056
    ds_read_b64_tr_b16 v[54:55], v13 offset:47104
    v_mfma_f32_16x16x32_bf16 v[216:219], v[56:59], v[108:111], v[216:219]
    s_add_u32 m0, s32, 106496
    s_add_u32 s33, s5, 163840
    v_mfma_f32_16x16x32_bf16 v[212:215], v[60:63], v[104:107], v[212:215]
    ds_read_b64_tr_b16 v[56:57], v14 offset:45056
    ds_read_b64_tr_b16 v[58:59], v14 offset:47104
    v_mfma_f32_16x16x32_bf16 v[220:223], v[60:63], v[108:111], v[220:223]
    buffer_load_dwordx4 v3, s[24:27], s33 offen nt lds
    s_waitcnt lgkmcnt(10)
    v_mfma_f32_16x16x32_bf16 v[192:195], v[20:23], v[112:115], v[192:195]
    ds_read_b64_tr_b16 v[60:61], v15 offset:45056
    ds_read_b64_tr_b16 v[62:63], v15 offset:47104
    v_mfma_f32_16x16x32_bf16 v[200:203], v[20:23], v[116:119], v[200:203]
    v_mfma_f32_16x16x32_bf16 v[196:199], v[36:39], v[112:115], v[196:199]
    v_mfma_f32_16x16x32_bf16 v[204:207], v[36:39], v[116:119], v[204:207]
    s_add_u32 m0, s32, 110592
    s_add_u32 s33, s5, 180224
    buffer_load_dwordx4 v3, s[24:27], s33 offen nt lds
    s_waitcnt vmcnt(12)
    s_barrier
    s_waitcnt lgkmcnt(8)
    v_mfma_f32_16x16x32_bf16 v[208:211], v[40:43], v[112:115], v[208:211]
    v_mfma_f32_16x16x32_bf16 v[216:219], v[40:43], v[116:119], v[216:219]
    v_mfma_f32_16x16x32_bf16 v[4:7], v[28:31], v[64:67], v[4:7]
    v_mfma_f32_16x16x32_bf16 v[8:11], v[28:31], v[68:71], v[8:11]
    v_mfma_f32_16x16x32_bf16 v[4:7], v[28:31], v[72:75], v[4:7]
    v_mfma_f32_16x16x32_bf16 v[8:11], v[28:31], v[76:79], v[8:11]
    v_mfma_f32_16x16x32_bf16 v[212:215], v[44:47], v[112:115], v[212:215]
    v_mfma_f32_16x16x32_bf16 v[220:223], v[44:47], v[116:119], v[220:223]
    s_waitcnt lgkmcnt(4)
    v_mfma_f32_16x16x32_bf16 v[192:195], v[48:51], v[120:123], v[192:195]
    ds_read_b64_tr_b16 v[20:21], v12 offset:49152
    ds_read_b64_tr_b16 v[22:23], v12 offset:51200
    v_mfma_f32_16x16x32_bf16 v[200:203], v[48:51], v[124:127], v[200:203]
    v_mfma_f32_16x16x32_bf16 v[196:199], v[52:55], v[120:123], v[196:199]
    ds_read_b64_tr_b16 v[36:37], v13 offset:49152
    ds_read_b64_tr_b16 v[38:39], v13 offset:51200
    v_mfma_f32_16x16x32_bf16 v[204:207], v[52:55], v[124:127], v[204:207]
    ds_read_b64_tr_b16 v[40:41], v14 offset:49152
    ds_read_b64_tr_b16 v[42:43], v14 offset:51200
    s_waitcnt lgkmcnt(6)
    v_mfma_f32_16x16x32_bf16 v[208:211], v[56:59], v[120:123], v[208:211]
    ds_read_b64_tr_b16 v[44:45], v15 offset:49152
    ds_read_b64_tr_b16 v[46:47], v15 offset:51200
    v_mfma_f32_16x16x32_bf16 v[216:219], v[56:59], v[124:127], v[216:219]
    s_add_u32 m0, s32, 114688
    s_add_u32 s33, s5, 196608
    v_mfma_f32_16x16x32_bf16 v[212:215], v[60:63], v[120:123], v[212:215]
    ds_read_b64_tr_b16 v[48:49], v12 offset:53248
    ds_read_b64_tr_b16 v[50:51], v12 offset:55296
    v_mfma_f32_16x16x32_bf16 v[220:223], v[60:63], v[124:127], v[220:223]
    buffer_load_dwordx4 v3, s[24:27], s33 offen nt lds
    s_waitcnt lgkmcnt(6)
    v_mfma_f32_16x16x32_bf16 v[224:227], v[20:23], v[96:99], v[224:227]
    ds_read_b64_tr_b16 v[52:53], v13 offset:53248
    ds_read_b64_tr_b16 v[54:55], v13 offset:55296
    v_mfma_f32_16x16x32_bf16 v[232:235], v[20:23], v[100:103], v[232:235]
    s_add_u32 m0, s32, 118784
    s_add_u32 s33, s5, 212992
    v_mfma_f32_16x16x32_bf16 v[228:231], v[36:39], v[96:99], v[228:231]
    ds_read_b64_tr_b16 v[56:57], v14 offset:53248
    ds_read_b64_tr_b16 v[58:59], v14 offset:55296
    v_mfma_f32_16x16x32_bf16 v[236:239], v[36:39], v[100:103], v[236:239]
    ds_read_b64_tr_b16 v[60:61], v15 offset:53248
    ds_read_b64_tr_b16 v[62:63], v15 offset:55296
    s_waitcnt lgkmcnt(8)
    v_mfma_f32_16x16x32_bf16 v[240:243], v[40:43], v[96:99], v[240:243]
    ds_read_b64_tr_b16 v[20:21], v12 offset:57344
    ds_read_b64_tr_b16 v[22:23], v12 offset:59392
    v_mfma_f32_16x16x32_bf16 v[248:251], v[40:43], v[100:103], v[248:251]
    buffer_load_dwordx4 v3, s[24:27], s33 offen nt lds
    v_mfma_f32_16x16x32_bf16 v[244:247], v[44:47], v[96:99], v[244:247]
    ds_read_b64_tr_b16 v[36:37], v13 offset:57344
    ds_read_b64_tr_b16 v[38:39], v13 offset:59392
    v_mfma_f32_16x16x32_bf16 v[252:255], v[44:47], v[100:103], v[252:255]
    s_waitcnt lgkmcnt(8)
    s_add_u32 m0, s32, 122880
    s_add_u32 s33, s5, 229376
    v_mfma_f32_16x16x32_bf16 v[224:227], v[48:51], v[104:107], v[224:227]
    ds_read_b64_tr_b16 v[40:41], v14 offset:57344
    ds_read_b64_tr_b16 v[42:43], v14 offset:59392
    v_mfma_f32_16x16x32_bf16 v[232:235], v[48:51], v[108:111], v[232:235]
    ds_read_b128 v[96:99], v25 offset:0
    v_mfma_f32_16x16x32_bf16 v[228:231], v[52:55], v[104:107], v[228:231]
    ds_read_b64_tr_b16 v[44:45], v15 offset:57344
    ds_read_b64_tr_b16 v[46:47], v15 offset:59392
    v_mfma_f32_16x16x32_bf16 v[236:239], v[52:55], v[108:111], v[236:239]
    ds_read_b64_tr_b16 v[48:49], v12 offset:61440
    ds_read_b64_tr_b16 v[50:51], v12 offset:63488
    s_waitcnt lgkmcnt(13)
    ds_read_b128 v[100:103], v25 offset:1024
    s_waitcnt lgkmcnt(12)
    v_mfma_f32_16x16x32_bf16 v[240:243], v[56:59], v[104:107], v[240:243]
    ds_read_b64_tr_b16 v[52:53], v13 offset:61440
    ds_read_b64_tr_b16 v[54:55], v13 offset:63488
    v_mfma_f32_16x16x32_bf16 v[248:251], v[56:59], v[108:111], v[248:251]
    buffer_load_dwordx4 v3, s[24:27], s33 offen nt lds
    v_mfma_f32_16x16x32_bf16 v[244:247], v[60:63], v[104:107], v[244:247]
    ds_read_b64_tr_b16 v[56:57], v14 offset:61440
    s_waitcnt lgkmcnt(13)
    ds_read_b64_tr_b16 v[58:59], v14 offset:63488
    v_mfma_f32_16x16x32_bf16 v[252:255], v[60:63], v[108:111], v[252:255]
    s_waitcnt lgkmcnt(12)
    s_add_u32 m0, s32, 126976
    s_add_u32 s33, s5, 245760
    v_mfma_f32_16x16x32_bf16 v[224:227], v[20:23], v[112:115], v[224:227]
    ds_read_b64_tr_b16 v[60:61], v15 offset:61440
    ds_read_b64_tr_b16 v[62:63], v15 offset:63488
    v_mfma_f32_16x16x32_bf16 v[232:235], v[20:23], v[116:119], v[232:235]
    buffer_load_dwordx4 v3, s[24:27], s33 offen nt lds
    v_mfma_f32_16x16x32_bf16 v[228:231], v[36:39], v[112:115], v[228:231]
    v_mfma_f32_16x16x32_bf16 v[236:239], v[36:39], v[116:119], v[236:239]
    s_waitcnt vmcnt(12)
    s_barrier
    s_waitcnt lgkmcnt(9)
    v_mfma_f32_16x16x32_bf16 v[240:243], v[40:43], v[112:115], v[240:243]
    v_mfma_f32_16x16x32_bf16 v[248:251], v[40:43], v[116:119], v[248:251]
    v_mfma_f32_16x16x32_bf16 v[4:7], v[28:31], v[80:83], v[4:7]
    v_mfma_f32_16x16x32_bf16 v[8:11], v[28:31], v[84:87], v[8:11]
    v_mfma_f32_16x16x32_bf16 v[4:7], v[28:31], v[88:91], v[4:7]
    v_mfma_f32_16x16x32_bf16 v[8:11], v[28:31], v[92:95], v[8:11]
    v_mfma_f32_16x16x32_bf16 v[244:247], v[44:47], v[112:115], v[244:247]
    v_mfma_f32_16x16x32_bf16 v[252:255], v[44:47], v[116:119], v[252:255]
    s_waitcnt lgkmcnt(4)
    v_mfma_f32_16x16x32_bf16 v[224:227], v[48:51], v[120:123], v[224:227]
    ds_read_b64_tr_b16 v[20:21], v16 offset:0
    ds_read_b64_tr_b16 v[22:23], v16 offset:2048
    v_mfma_f32_16x16x32_bf16 v[232:235], v[48:51], v[124:127], v[232:235]
    v_mfma_f32_16x16x32_bf16 v[228:231], v[52:55], v[120:123], v[228:231]
    ds_read_b64_tr_b16 v[36:37], v17 offset:0
    ds_read_b64_tr_b16 v[38:39], v17 offset:2048
    v_mfma_f32_16x16x32_bf16 v[236:239], v[52:55], v[124:127], v[236:239]
    ds_read_b128 v[104:107], v25 offset:8192
    s_waitcnt lgkmcnt(5)
    s_add_u32 m0, s32, 0
    v_mfma_f32_16x16x32_bf16 v[240:243], v[56:59], v[120:123], v[240:243]
    ds_read_b64_tr_b16 v[40:41], v16 offset:4096
    ds_read_b64_tr_b16 v[42:43], v16 offset:6144
    v_mfma_f32_16x16x32_bf16 v[248:251], v[56:59], v[124:127], v[248:251]
    ds_read_b128 v[108:111], v25 offset:9216
    s_add_u32 s33, s6, 131072
    v_mfma_f32_16x16x32_bf16 v[244:247], v[60:63], v[120:123], v[244:247]
    ds_read_b64_tr_b16 v[44:45], v17 offset:4096
    ds_read_b64_tr_b16 v[46:47], v17 offset:6144
    v_mfma_f32_16x16x32_bf16 v[252:255], v[60:63], v[124:127], v[252:255]
    buffer_load_dwordx4 v3, s[24:27], s33 offen nt lds
    s_cmp_lg_u64 s[44:45], 0
    s_cbranch_scc1 L_rescale
L_resc_back:
    s_waitcnt lgkmcnt(6)
    v_mfma_f32_16x16x32_bf16 v[128:131], v[20:23], v[64:67], v[128:131]
    ds_read_b64_tr_b16 v[48:49], v16 offset:8192
    ds_read_b64_tr_b16 v[50:51], v16 offset:10240
    v_mfma_f32_16x16x32_bf16 v[136:139], v[20:23], v[68:71], v[136:139]
    s_add_u32 m0, s32, 4096
    s_add_u32 s33, s6, 147456
    v_mfma_f32_16x16x32_bf16 v[132:135], v[36:39], v[64:67], v[132:135]
    ds_read_b64_tr_b16 v[52:53], v17 offset:8192
    ds_read_b64_tr_b16 v[54:55], v17 offset:10240
    v_mfma_f32_16x16x32_bf16 v[140:143], v[36:39], v[68:71], v[140:143]
    buffer_load_dwordx4 v3, s[24:27], s33 offen nt lds
    s_waitcnt lgkmcnt(4)
    v_mfma_f32_16x16x32_bf16 v[128:131], v[40:43], v[72:75], v[128:131]
    ds_read_b64_tr_b16 v[56:57], v16 offset:12288
    ds_read_b64_tr_b16 v[58:59], v16 offset:14336
    v_mfma_f32_16x16x32_bf16 v[136:139], v[40:43], v[76:79], v[136:139]
    v_mfma_f32_16x16x32_bf16 v[132:135], v[44:47], v[72:75], v[132:135]
    v_mfma_f32_16x16x32_bf16 v[140:143], v[44:47], v[76:79], v[140:143]
    s_add_u32 m0, s32, 8192
    s_add_u32 s33, s6, 163840
    buffer_load_dwordx4 v3, s[24:27], s33 offen nt lds
    s_add_u32 m0, s32, 12288
    s_add_u32 s33, s6, 180224
    buffer_load_dwordx4 v3, s[24:27], s33 offen nt lds
    s_waitcnt vmcnt(12)
    s_barrier
    ds_read_b64_tr_b16 v[60:61], v17 offset:12288
    ds_read_b64_tr_b16 v[62:63], v17 offset:14336
    s_waitcnt lgkmcnt(4)
    v_mfma_f32_16x16x32_bf16 v[128:131], v[48:51], v[80:83], v[128:131]
    ds_read_b64_tr_b16 v[20:21], v16 offset:16384
    ds_read_b64_tr_b16 v[22:23], v16 offset:18432
    v_mfma_f32_16x16x32_bf16 v[136:139], v[48:51], v[84:87], v[136:139]
    ds_read_b128 v[112:115], v25 offset:16384
    v_mfma_f32_16x16x32_bf16 v[132:135], v[52:55], v[80:83], v[132:135]
    ds_read_b64_tr_b16 v[36:37], v17 offset:16384
    ds_read_b64_tr_b16 v[38:39], v17 offset:18432
    v_mfma_f32_16x16x32_bf16 v[140:143], v[52:55], v[84:87], v[140:143]
    ds_read_b128 v[116:119], v25 offset:17408
    s_waitcnt lgkmcnt(6)
    v_mfma_f32_16x16x32_bf16 v[128:131], v[56:59], v[88:91], v[128:131]
    ds_read_b64_tr_b16 v[40:41], v16 offset:20480
    ds_read_b64_tr_b16 v[42:43], v16 offset:22528
    v_mfma_f32_16x16x32_bf16 v[136:139], v[56:59], v[92:95], v[136:139]
    ds_read_b128 v[120:123], v25 offset:24576
    v_mfma_f32_16x16x32_bf16 v[132:135], v[60:63], v[88:91], v[132:135]
    ds_read_b64_tr_b16 v[44:45], v17 offset:20480
    ds_read_b64_tr_b16 v[46:47], v17 offset:22528
    v_mfma_f32_16x16x32_bf16 v[140:143], v[60:63], v[92:95], v[140:143]
    ds_read_b128 v[124:127], v25 offset:25600
    s_waitcnt lgkmcnt(7)
    v_mfma_f32_16x16x32_bf16 v[128:131], v[20:23], v[96:99], v[128:131]
    ds_read_b64_tr_b16 v[48:49], v16 offset:24576
    ds_read_b64_tr_b16 v[50:51], v16 offset:26624
    v_mfma_f32_16x16x32_bf16 v[136:139], v[20:23], v[100:103], v[136:139]
    v_mfma_f32_16x16x32_bf16 v[4:7], v[28:31], v[96:99], v[4:7]
    v_mfma_f32_16x16x32_bf16 v[8:11], v[28:31], v[100:103], v[8:11]
    v_mfma_f32_16x16x32_bf16 v[132:135], v[36:39], v[96:99], v[132:135]
    ds_read_b64_tr_b16 v[52:53], v17 offset:24576
    ds_read_b64_tr_b16 v[54:55], v17 offset:26624
    v_mfma_f32_16x16x32_bf16 v[140:143], v[36:39], v[100:103], v[140:143]
    s_waitcnt lgkmcnt(5)
    v_mfma_f32_16x16x32_bf16 v[128:131], v[40:43], v[104:107], v[128:131]
    ds_read_b64_tr_b16 v[56:57], v16 offset:28672
    ds_read_b64_tr_b16 v[58:59], v16 offset:30720
    v_mfma_f32_16x16x32_bf16 v[136:139], v[40:43], v[108:111], v[136:139]
    v_mfma_f32_16x16x32_bf16 v[4:7], v[28:31], v[104:107], v[4:7]
    v_mfma_f32_16x16x32_bf16 v[8:11], v[28:31], v[108:111], v[8:11]
    v_mfma_f32_16x16x32_bf16 v[132:135], v[44:47], v[104:107], v[132:135]
    ds_read_b64_tr_b16 v[60:61], v17 offset:28672
    ds_read_b64_tr_b16 v[62:63], v17 offset:30720
    v_mfma_f32_16x16x32_bf16 v[140:143], v[44:47], v[108:111], v[140:143]
    s_waitcnt lgkmcnt(4)
    v_mfma_f32_16x16x32_bf16 v[128:131], v[48:51], v[112:115], v[128:131]
    ds_read_b64_tr_b16 v[20:21], v18 offset:0
    ds_read_b64_tr_b16 v[22:23], v18 offset:2048
    v_mfma_f32_16x16x32_bf16 v[136:139], v[48:51], v[116:119], v[136:139]
    v_mfma_f32_16x16x32_bf16 v[4:7], v[28:31], v[112:115], v[4:7]
    v_mfma_f32_16x16x32_bf16 v[8:11], v[28:31], v[116:119], v[8:11]
    v_mfma_f32_16x16x32_bf16 v[132:135], v[52:55], v[112:115], v[132:135]
    ds_read_b64_tr_b16 v[36:37], v19 offset:0
    ds_read_b64_tr_b16 v[38:39], v19 offset:2048
    v_mfma_f32_16x16x32_bf16 v[140:143], v[52:55], v[116:119], v[140:143]
    s_waitcnt lgkmcnt(4)
    v_mfma_f32_16x16x32_bf16 v[128:131], v[56:59], v[120:123], v[128:131]
    ds_read_b64_tr_b16 v[40:41], v18 offset:4096
    ds_read_b64_tr_b16 v[42:43], v18 offset:6144
    v_mfma_f32_16x16x32_bf16 v[136:139], v[56:59], v[124:127], v[136:139]
    v_mfma_f32_16x16x32_bf16 v[4:7], v[28:31], v[120:123], v[4:7]
    v_mfma_f32_16x16x32_bf16 v[8:11], v[28:31], v[124:127], v[8:11]
    v_mfma_f32_16x16x32_bf16 v[132:135], v[60:63], v[120:123], v[132:135]
    ds_read_b64_tr_b16 v[44:45], v19 offset:4096
    ds_read_b64_tr_b16 v[46:47], v19 offset:6144
    v_mfma_f32_16x16x32_bf16 v[140:143], v[60:63], v[124:127], v[140:143]
    s_waitcnt lgkmcnt(4)
    v_mfma_f32_16x16x32_bf16 v[144:147], v[20:23], v[64:67], v[144:147]
    ds_read_b64_tr_b16 v[48:49], v18 offset:8192
    ds_read_b64_tr_b16 v[50:51], v18 offset:10240
    v_mfma_f32_16x16x32_bf16 v[152:155], v[20:23], v[68:71], v[152:155]
    v_mfma_f32_16x16x32_bf16 v[148:151], v[36:39], v[64:67], v[148:151]
    ds_read_b64_tr_b16 v[52:53], v19 offset:8192
    ds_read_b64_tr_b16 v[54:55], v19 offset:10240
    v_mfma_f32_16x16x32_bf16 v[156:159], v[36:39], v[68:71], v[156:159]
    s_waitcnt lgkmcnt(4)
    v_rcp_f32 v34, v4
    v_rcp_f32 v35, v8
    v_mfma_f32_16x16x32_bf16 v[144:147], v[40:43], v[72:75], v[144:147]
    ds_read_b64_tr_b16 v[56:57], v18 offset:12288
    ds_read_b64_tr_b16 v[58:59], v18 offset:14336
    v_mfma_f32_16x16x32_bf16 v[152:155], v[40:43], v[76:79], v[152:155]
    v_mul_f32 v128, v34, v128
    v_mul_f32 v129, v34, v129
    v_mfma_f32_16x16x32_bf16 v[148:151], v[44:47], v[72:75], v[148:151]
    ds_read_b64_tr_b16 v[60:61], v19 offset:12288
    ds_read_b64_tr_b16 v[62:63], v19 offset:14336
    v_mfma_f32_16x16x32_bf16 v[156:159], v[44:47], v[76:79], v[156:159]
    s_waitcnt lgkmcnt(4)
    v_mul_f32 v130, v34, v130
    v_mul_f32 v131, v34, v131
    v_mfma_f32_16x16x32_bf16 v[144:147], v[48:51], v[80:83], v[144:147]
    ds_read_b64_tr_b16 v[20:21], v18 offset:16384
    ds_read_b64_tr_b16 v[22:23], v18 offset:18432
    v_mfma_f32_16x16x32_bf16 v[152:155], v[48:51], v[84:87], v[152:155]
    v_mul_f32 v132, v34, v132
    v_mul_f32 v133, v34, v133
    v_mfma_f32_16x16x32_bf16 v[148:151], v[52:55], v[80:83], v[148:151]
    ds_read_b64_tr_b16 v[36:37], v19 offset:16384
    ds_read_b64_tr_b16 v[38:39], v19 offset:18432
    v_mfma_f32_16x16x32_bf16 v[156:159], v[52:55], v[84:87], v[156:159]
    s_waitcnt lgkmcnt(4)
    v_mul_f32 v134, v34, v134
    v_mul_f32 v135, v34, v135
    v_mfma_f32_16x16x32_bf16 v[144:147], v[56:59], v[88:91], v[144:147]
    ds_read_b64_tr_b16 v[40:41], v18 offset:20480
    ds_read_b64_tr_b16 v[42:43], v18 offset:22528
    v_mfma_f32_16x16x32_bf16 v[152:155], v[56:59], v[92:95], v[152:155]
    v_cvt_pk_bf16_f32 v128, v128, v129
    v_cvt_pk_bf16_f32 v129, v130, v131
    v_mfma_f32_16x16x32_bf16 v[148:151], v[60:63], v[88:91], v[148:151]
    ds_read_b64_tr_b16 v[44:45], v19 offset:20480
    ds_read_b64_tr_b16 v[46:47], v19 offset:22528
    v_mfma_f32_16x16x32_bf16 v[156:159], v[60:63], v[92:95], v[156:159]
    s_waitcnt lgkmcnt(4)
    v_cvt_pk_bf16_f32 v130, v132, v133
    v_cvt_pk_bf16_f32 v131, v134, v135
    v_mfma_f32_16x16x32_bf16 v[144:147], v[20:23], v[96:99], v[144:147]
    ds_read_b64_tr_b16 v[48:49], v18 offset:24576
    ds_read_b64_tr_b16 v[50:51], v18 offset:26624
    v_mfma_f32_16x16x32_bf16 v[152:155], v[20:23], v[100:103], v[152:155]
    v_permlane16_swap_b32 v128, v130
    v_mfma_f32_16x16x32_bf16 v[148:151], v[36:39], v[96:99], v[148:151]
    ds_read_b64_tr_b16 v[52:53], v19 offset:24576
    ds_read_b64_tr_b16 v[54:55], v19 offset:26624
    v_mfma_f32_16x16x32_bf16 v[156:159], v[36:39], v[100:103], v[156:159]
    s_waitcnt lgkmcnt(4)
    v_permlane16_swap_b32 v129, v131
    v_mfma_f32_16x16x32_bf16 v[144:147], v[40:43], v[104:107], v[144:147]
    ds_read_b64_tr_b16 v[56:57], v18 offset:28672
    ds_read_b64_tr_b16 v[58:59], v18 offset:30720
    v_mfma_f32_16x16x32_bf16 v[152:155], v[40:43], v[108:111], v[152:155]
    buffer_store_dwordx4 v[128:131], v24, s[28:31], s4 offen offset:0 sc1
    v_mul_f32 v136, v35, v136
    v_mul_f32 v137, v35, v137
    v_mfma_f32_16x16x32_bf16 v[148:151], v[44:47], v[104:107], v[148:151]
    ds_read_b64_tr_b16 v[60:61], v19 offset:28672
    ds_read_b64_tr_b16 v[62:63], v19 offset:30720
    v_mfma_f32_16x16x32_bf16 v[156:159], v[44:47], v[108:111], v[156:159]
    s_waitcnt lgkmcnt(4)
    v_mul_f32 v138, v35, v138
    v_mul_f32 v139, v35, v139
    v_mfma_f32_16x16x32_bf16 v[144:147], v[48:51], v[112:115], v[144:147]
    v_mul_f32 v140, v35, v140
    v_mul_f32 v141, v35, v141
    v_mfma_f32_16x16x32_bf16 v[152:155], v[48:51], v[116:119], v[152:155]
    s_waitcnt vmcnt(9)
    s_waitcnt vmcnt(5)
    s_barrier
    ds_read_b64_tr_b16 v[20:21], v16 offset:32768
    ds_read_b64_tr_b16 v[22:23], v16 offset:34816
    v_mfma_f32_16x16x32_bf16 v[148:151], v[52:55], v[112:115], v[148:151]
    ds_read_b64_tr_b16 v[36:37], v17 offset:32768
    ds_read_b64_tr_b16 v[38:39], v17 offset:34816
    v_mfma_f32_16x16x32_bf16 v[156:159], v[52:55], v[116:119], v[156:159]
    s_waitcnt lgkmcnt(4)
    v_mul_f32 v142, v35, v142
    v_mul_f32 v143, v35, v143
    v_mfma_f32_16x16x32_bf16 v[144:147], v[56:59], v[120:123], v[144:147]
    ds_read_b64_tr_b16 v[40:41], v16 offset:36864
    ds_read_b64_tr_b16 v[42:43], v16 offset:38912
    v_mfma_f32_16x16x32_bf16 v[152:155], v[56:59], v[124:127], v[152:155]
    v_cvt_pk_bf16_f32 v136, v136, v137
    v_cvt_pk_bf16_f32 v137, v138, v139
    v_mfma_f32_16x16x32_bf16 v[148:151], v[60:63], v[120:123], v[148:151]
    ds_read_b64_tr_b16 v[44:45], v17 offset:36864
    ds_read_b64_tr_b16 v[46:47], v17 offset:38912
    v_mfma_f32_16x16x32_bf16 v[156:159], v[60:63], v[124:127], v[156:159]
    s_waitcnt lgkmcnt(4)
    v_cvt_pk_bf16_f32 v138, v140, v141
    v_cvt_pk_bf16_f32 v139, v142, v143
    v_mfma_f32_16x16x32_bf16 v[160:163], v[20:23], v[64:67], v[160:163]
    ds_read_b64_tr_b16 v[48:49], v16 offset:40960
    ds_read_b64_tr_b16 v[50:51], v16 offset:43008
    v_mfma_f32_16x16x32_bf16 v[168:171], v[20:23], v[68:71], v[168:171]
    v_permlane16_swap_b32 v136, v138
    v_mfma_f32_16x16x32_bf16 v[164:167], v[36:39], v[64:67], v[164:167]
    ds_read_b64_tr_b16 v[52:53], v17 offset:40960
    ds_read_b64_tr_b16 v[54:55], v17 offset:43008
    v_mfma_f32_16x16x32_bf16 v[172:175], v[36:39], v[68:71], v[172:175]
    s_waitcnt lgkmcnt(4)
    v_permlane16_swap_b32 v137, v139
    v_mfma_f32_16x16x32_bf16 v[160:163], v[40:43], v[72:75], v[160:163]
    ds_read_b64_tr_b16 v[56:57], v16 offset:45056
    ds_read_b64_tr_b16 v[58:59], v16 offset:47104
    v_mfma_f32_16x16x32_bf16 v[168:171], v[40:43], v[76:79], v[168:171]
    buffer_store_dwordx4 v[136:139], v24, s[28:31], s8 offen offset:0 sc1
    v_mul_f32 v144, v34, v144
    v_mul_f32 v145, v34, v145
    v_mfma_f32_16x16x32_bf16 v[164:167], v[44:47], v[72:75], v[164:167]
    ds_read_b64_tr_b16 v[60:61], v17 offset:45056
    ds_read_b64_tr_b16 v[62:63], v17 offset:47104
    v_mfma_f32_16x16x32_bf16 v[172:175], v[44:47], v[76:79], v[172:175]
    s_waitcnt lgkmcnt(4)
    v_mul_f32 v146, v34, v146
    v_mul_f32 v147, v34, v147
    v_mfma_f32_16x16x32_bf16 v[160:163], v[48:51], v[80:83], v[160:163]
    ds_read_b64_tr_b16 v[20:21], v16 offset:49152
    ds_read_b64_tr_b16 v[22:23], v16 offset:51200
    v_mfma_f32_16x16x32_bf16 v[168:171], v[48:51], v[84:87], v[168:171]
    v_mul_f32 v148, v34, v148
    v_mul_f32 v149, v34, v149
    v_mfma_f32_16x16x32_bf16 v[164:167], v[52:55], v[80:83], v[164:167]
    ds_read_b64_tr_b16 v[36:37], v17 offset:49152
    ds_read_b64_tr_b16 v[38:39], v17 offset:51200
    v_mfma_f32_16x16x32_bf16 v[172:175], v[52:55], v[84:87], v[172:175]
    s_waitcnt lgkmcnt(4)
    v_mul_f32 v150, v34, v150
    v_mul_f32 v151, v34, v151
    v_mfma_f32_16x16x32_bf16 v[160:163], v[56:59], v[88:91], v[160:163]
    ds_read_b64_tr_b16 v[40:41], v16 offset:53248
    ds_read_b64_tr_b16 v[42:43], v16 offset:55296
    v_mfma_f32_16x16x32_bf16 v[168:171], v[56:59], v[92:95], v[168:171]
    v_cvt_pk_bf16_f32 v144, v144, v145
    v_cvt_pk_bf16_f32 v145, v146, v147
    v_mfma_f32_16x16x32_bf16 v[164:167], v[60:63], v[88:91], v[164:167]
    ds_read_b64_tr_b16 v[44:45], v17 offset:53248
    ds_read_b64_tr_b16 v[46:47], v17 offset:55296
    v_mfma_f32_16x16x32_bf16 v[172:175], v[60:63], v[92:95], v[172:175]
    s_waitcnt lgkmcnt(4)
    v_cvt_pk_bf16_f32 v146, v148, v149
    v_cvt_pk_bf16_f32 v147, v150, v151
    v_mfma_f32_16x16x32_bf16 v[160:163], v[20:23], v[96:99], v[160:163]
    ds_read_b64_tr_b16 v[48:49], v16 offset:57344
    ds_read_b64_tr_b16 v[50:51], v16 offset:59392
    v_mfma_f32_16x16x32_bf16 v[168:171], v[20:23], v[100:103], v[168:171]
    v_permlane16_swap_b32 v144, v146
    v_mfma_f32_16x16x32_bf16 v[164:167], v[36:39], v[96:99], v[164:167]
    ds_read_b64_tr_b16 v[52:53], v17 offset:57344
    ds_read_b64_tr_b16 v[54:55], v17 offset:59392
    v_mfma_f32_16x16x32_bf16 v[172:175], v[36:39], v[100:103], v[172:175]
    s_waitcnt lgkmcnt(4)
    v_permlane16_swap_b32 v145, v147
    v_mfma_f32_16x16x32_bf16 v[160:163], v[40:43], v[104:107], v[160:163]
    ds_read_b64_tr_b16 v[56:57], v16 offset:61440
    ds_read_b64_tr_b16 v[58:59], v16 offset:63488
    v_mfma_f32_16x16x32_bf16 v[168:171], v[40:43], v[108:111], v[168:171]
    buffer_store_dwordx4 v[144:147], v24, s[28:31], s4 offen offset:64 sc1
    v_mul_f32 v152, v35, v152
    v_mul_f32 v153, v35, v153
    v_mfma_f32_16x16x32_bf16 v[164:167], v[44:47], v[104:107], v[164:167]
    ds_read_b64_tr_b16 v[60:61], v17 offset:61440
    ds_read_b64_tr_b16 v[62:63], v17 offset:63488
    v_mfma_f32_16x16x32_bf16 v[172:175], v[44:47], v[108:111], v[172:175]
    s_waitcnt lgkmcnt(4)
    v_mul_f32 v154, v35, v154
    v_mul_f32 v155, v35, v155
    v_mfma_f32_16x16x32_bf16 v[160:163], v[48:51], v[112:115], v[160:163]
    ds_read_b64_tr_b16 v[20:21], v18 offset:32768
    ds_read_b64_tr_b16 v[22:23], v18 offset:34816
    v_mfma_f32_16x16x32_bf16 v[168:171], v[48:51], v[116:119], v[168:171]
    v_mul_f32 v156, v35, v156
    v_mul_f32 v157, v35, v157
    v_mfma_f32_16x16x32_bf16 v[164:167], v[52:55], v[112:115], v[164:167]
    ds_read_b64_tr_b16 v[36:37], v19 offset:32768
    ds_read_b64_tr_b16 v[38:39], v19 offset:34816
    v_mfma_f32_16x16x32_bf16 v[172:175], v[52:55], v[116:119], v[172:175]
    s_waitcnt lgkmcnt(4)
    v_mul_f32 v158, v35, v158
    v_mul_f32 v159, v35, v159
    v_mfma_f32_16x16x32_bf16 v[160:163], v[56:59], v[120:123], v[160:163]
    ds_read_b64_tr_b16 v[40:41], v18 offset:36864
    ds_read_b64_tr_b16 v[42:43], v18 offset:38912
    v_mfma_f32_16x16x32_bf16 v[168:171], v[56:59], v[124:127], v[168:171]
    v_cvt_pk_bf16_f32 v152, v152, v153
    v_cvt_pk_bf16_f32 v153, v154, v155
    v_mfma_f32_16x16x32_bf16 v[164:167], v[60:63], v[120:123], v[164:167]
    ds_read_b64_tr_b16 v[44:45], v19 offset:36864
    ds_read_b64_tr_b16 v[46:47], v19 offset:38912
    v_mfma_f32_16x16x32_bf16 v[172:175], v[60:63], v[124:127], v[172:175]
    s_waitcnt lgkmcnt(4)
    v_cvt_pk_bf16_f32 v154, v156, v157
    v_cvt_pk_bf16_f32 v155, v158, v159
    v_mfma_f32_16x16x32_bf16 v[176:179], v[20:23], v[64:67], v[176:179]
    ds_read_b64_tr_b16 v[48:49], v18 offset:40960
    ds_read_b64_tr_b16 v[50:51], v18 offset:43008
    v_mfma_f32_16x16x32_bf16 v[184:187], v[20:23], v[68:71], v[184:187]
    v_permlane16_swap_b32 v152, v154
    v_mfma_f32_16x16x32_bf16 v[180:183], v[36:39], v[64:67], v[180:183]
    ds_read_b64_tr_b16 v[52:53], v19 offset:40960
    ds_read_b64_tr_b16 v[54:55], v19 offset:43008
    v_mfma_f32_16x16x32_bf16 v[188:191], v[36:39], v[68:71], v[188:191]
    s_waitcnt lgkmcnt(4)
    v_permlane16_swap_b32 v153, v155
    v_mfma_f32_16x16x32_bf16 v[176:179], v[40:43], v[72:75], v[176:179]
    ds_read_b64_tr_b16 v[56:57], v18 offset:45056
    ds_read_b64_tr_b16 v[58:59], v18 offset:47104
    v_mfma_f32_16x16x32_bf16 v[184:187], v[40:43], v[76:79], v[184:187]
    buffer_store_dwordx4 v[152:155], v24, s[28:31], s8 offen offset:64 sc1
    v_mul_f32 v160, v34, v160
    v_mul_f32 v161, v34, v161
    v_mfma_f32_16x16x32_bf16 v[180:183], v[44:47], v[72:75], v[180:183]
    ds_read_b64_tr_b16 v[60:61], v19 offset:45056
    ds_read_b64_tr_b16 v[62:63], v19 offset:47104
    v_mfma_f32_16x16x32_bf16 v[188:191], v[44:47], v[76:79], v[188:191]
    s_waitcnt lgkmcnt(4)
    v_mul_f32 v162, v34, v162
    v_mul_f32 v163, v34, v163
    v_mfma_f32_16x16x32_bf16 v[176:179], v[48:51], v[80:83], v[176:179]
    ds_read_b64_tr_b16 v[20:21], v18 offset:49152
    ds_read_b64_tr_b16 v[22:23], v18 offset:51200
    v_mfma_f32_16x16x32_bf16 v[184:187], v[48:51], v[84:87], v[184:187]
    v_mul_f32 v164, v34, v164
    v_mul_f32 v165, v34, v165
    v_mfma_f32_16x16x32_bf16 v[180:183], v[52:55], v[80:83], v[180:183]
    ds_read_b64_tr_b16 v[36:37], v19 offset:49152
    ds_read_b64_tr_b16 v[38:39], v19 offset:51200
    v_mfma_f32_16x16x32_bf16 v[188:191], v[52:55], v[84:87], v[188:191]
    s_waitcnt lgkmcnt(4)
    v_mul_f32 v166, v34, v166
    v_mul_f32 v167, v34, v167
    v_mfma_f32_16x16x32_bf16 v[176:179], v[56:59], v[88:91], v[176:179]
    ds_read_b64_tr_b16 v[40:41], v18 offset:53248
    ds_read_b64_tr_b16 v[42:43], v18 offset:55296
    v_mfma_f32_16x16x32_bf16 v[184:187], v[56:59], v[92:95], v[184:187]
    v_cvt_pk_bf16_f32 v160, v160, v161
    v_cvt_pk_bf16_f32 v161, v162, v163
    v_mfma_f32_16x16x32_bf16 v[180:183], v[60:63], v[88:91], v[180:183]
    ds_read_b64_tr_b16 v[44:45], v19 offset:53248
    ds_read_b64_tr_b16 v[46:47], v19 offset:55296
    v_mfma_f32_16x16x32_bf16 v[188:191], v[60:63], v[92:95], v[188:191]
    s_waitcnt lgkmcnt(4)
    v_cvt_pk_bf16_f32 v162, v164, v165
    v_cvt_pk_bf16_f32 v163, v166, v167
    v_mfma_f32_16x16x32_bf16 v[176:179], v[20:23], v[96:99], v[176:179]
    ds_read_b64_tr_b16 v[48:49], v18 offset:57344
    ds_read_b64_tr_b16 v[50:51], v18 offset:59392
    v_mfma_f32_16x16x32_bf16 v[184:187], v[20:23], v[100:103], v[184:187]
    v_permlane16_swap_b32 v160, v162
    v_mfma_f32_16x16x32_bf16 v[180:183], v[36:39], v[96:99], v[180:183]
    ds_read_b64_tr_b16 v[52:53], v19 offset:57344
    ds_read_b64_tr_b16 v[54:55], v19 offset:59392
    v_mfma_f32_16x16x32_bf16 v[188:191], v[36:39], v[100:103], v[188:191]
    s_waitcnt lgkmcnt(4)
    v_permlane16_swap_b32 v161, v163
    v_mfma_f32_16x16x32_bf16 v[176:179], v[40:43], v[104:107], v[176:179]
    ds_read_b64_tr_b16 v[56:57], v18 offset:61440
    ds_read_b64_tr_b16 v[58:59], v18 offset:63488
    v_mfma_f32_16x16x32_bf16 v[184:187], v[40:43], v[108:111], v[184:187]
    buffer_store_dwordx4 v[160:163], v24, s[28:31], s5 offen offset:0 sc1
    v_mul_f32 v168, v35, v168
    v_mul_f32 v169, v35, v169
    v_mfma_f32_16x16x32_bf16 v[180:183], v[44:47], v[104:107], v[180:183]
    ds_read_b64_tr_b16 v[60:61], v19 offset:61440
    ds_read_b64_tr_b16 v[62:63], v19 offset:63488
    v_mfma_f32_16x16x32_bf16 v[188:191], v[44:47], v[108:111], v[188:191]
    s_waitcnt lgkmcnt(4)
    v_mul_f32 v170, v35, v170
    v_mul_f32 v171, v35, v171
    v_mfma_f32_16x16x32_bf16 v[176:179], v[48:51], v[112:115], v[176:179]
    v_mul_f32 v172, v35, v172
    v_mul_f32 v173, v35, v173
    v_mfma_f32_16x16x32_bf16 v[184:187], v[48:51], v[116:119], v[184:187]
    s_waitcnt vmcnt(5)
    s_barrier
    ds_read_b64_tr_b16 v[20:21], v12 offset:0
    ds_read_b64_tr_b16 v[22:23], v12 offset:2048
    v_mfma_f32_16x16x32_bf16 v[180:183], v[52:55], v[112:115], v[180:183]
    ds_read_b64_tr_b16 v[36:37], v13 offset:0
    ds_read_b64_tr_b16 v[38:39], v13 offset:2048
    v_mfma_f32_16x16x32_bf16 v[188:191], v[52:55], v[116:119], v[188:191]
    s_waitcnt lgkmcnt(4)
    v_mul_f32 v174, v35, v174
    v_mul_f32 v175, v35, v175
    v_mfma_f32_16x16x32_bf16 v[176:179], v[56:59], v[120:123], v[176:179]
    ds_read_b64_tr_b16 v[40:41], v12 offset:4096
    ds_read_b64_tr_b16 v[42:43], v12 offset:6144
    v_mfma_f32_16x16x32_bf16 v[184:187], v[56:59], v[124:127], v[184:187]
    v_cvt_pk_bf16_f32 v168, v168, v169
    v_cvt_pk_bf16_f32 v169, v170, v171
    v_mfma_f32_16x16x32_bf16 v[180:183], v[60:63], v[120:123], v[180:183]
    ds_read_b64_tr_b16 v[44:45], v13 offset:4096
    ds_read_b64_tr_b16 v[46:47], v13 offset:6144
    v_mfma_f32_16x16x32_bf16 v[188:191], v[60:63], v[124:127], v[188:191]
    s_waitcnt lgkmcnt(4)
    v_cvt_pk_bf16_f32 v170, v172, v173
    v_cvt_pk_bf16_f32 v171, v174, v175
    v_mfma_f32_16x16x32_bf16 v[192:195], v[20:23], v[64:67], v[192:195]
    ds_read_b64_tr_b16 v[48:49], v12 offset:8192
    ds_read_b64_tr_b16 v[50:51], v12 offset:10240
    v_mfma_f32_16x16x32_bf16 v[200:203], v[20:23], v[68:71], v[200:203]
    v_permlane16_swap_b32 v168, v170
    v_mfma_f32_16x16x32_bf16 v[196:199], v[36:39], v[64:67], v[196:199]
    ds_read_b64_tr_b16 v[52:53], v13 offset:8192
    ds_read_b64_tr_b16 v[54:55], v13 offset:10240
    v_mfma_f32_16x16x32_bf16 v[204:207], v[36:39], v[68:71], v[204:207]
    s_waitcnt lgkmcnt(4)
    v_permlane16_swap_b32 v169, v171
    v_mfma_f32_16x16x32_bf16 v[192:195], v[40:43], v[72:75], v[192:195]
    ds_read_b64_tr_b16 v[56:57], v12 offset:12288
    ds_read_b64_tr_b16 v[58:59], v12 offset:14336
    v_mfma_f32_16x16x32_bf16 v[200:203], v[40:43], v[76:79], v[200:203]
    buffer_store_dwordx4 v[168:171], v24, s[28:31], s9 offen offset:0 sc1
    v_mul_f32 v176, v34, v176
    v_mul_f32 v177, v34, v177
    v_mfma_f32_16x16x32_bf16 v[196:199], v[44:47], v[72:75], v[196:199]
    ds_read_b64_tr_b16 v[60:61], v13 offset:12288
    ds_read_b64_tr_b16 v[62:63], v13 offset:14336
    v_mfma_f32_16x16x32_bf16 v[204:207], v[44:47], v[76:79], v[204:207]
    s_waitcnt lgkmcnt(4)
    v_mul_f32 v178, v34, v178
    v_mul_f32 v179, v34, v179
    v_mfma_f32_16x16x32_bf16 v[192:195], v[48:51], v[80:83], v[192:195]
    ds_read_b64_tr_b16 v[20:21], v12 offset:16384
    ds_read_b64_tr_b16 v[22:23], v12 offset:18432
    v_mfma_f32_16x16x32_bf16 v[200:203], v[48:51], v[84:87], v[200:203]
    v_mul_f32 v180, v34, v180
    v_mul_f32 v181, v34, v181
    v_mfma_f32_16x16x32_bf16 v[196:199], v[52:55], v[80:83], v[196:199]
    ds_read_b64_tr_b16 v[36:37], v13 offset:16384
    ds_read_b64_tr_b16 v[38:39], v13 offset:18432
    v_mfma_f32_16x16x32_bf16 v[204:207], v[52:55], v[84:87], v[204:207]
    s_waitcnt lgkmcnt(4)
    v_mul_f32 v182, v34, v182
    v_mul_f32 v183, v34, v183
    v_mfma_f32_16x16x32_bf16 v[192:195], v[56:59], v[88:91], v[192:195]
    ds_read_b64_tr_b16 v[40:41], v12 offset:20480
    ds_read_b64_tr_b16 v[42:43], v12 offset:22528
    v_mfma_f32_16x16x32_bf16 v[200:203], v[56:59], v[92:95], v[200:203]
    v_cvt_pk_bf16_f32 v176, v176, v177
    v_cvt_pk_bf16_f32 v177, v178, v179
    v_mfma_f32_16x16x32_bf16 v[196:199], v[60:63], v[88:91], v[196:199]
    ds_read_b64_tr_b16 v[44:45], v13 offset:20480
    ds_read_b64_tr_b16 v[46:47], v13 offset:22528
    v_mfma_f32_16x16x32_bf16 v[204:207], v[60:63], v[92:95], v[204:207]
    s_waitcnt lgkmcnt(4)
    v_cvt_pk_bf16_f32 v178, v180, v181
    v_cvt_pk_bf16_f32 v179, v182, v183
    v_mfma_f32_16x16x32_bf16 v[192:195], v[20:23], v[96:99], v[192:195]
    ds_read_b64_tr_b16 v[48:49], v12 offset:24576
    ds_read_b64_tr_b16 v[50:51], v12 offset:26624
    v_mfma_f32_16x16x32_bf16 v[200:203], v[20:23], v[100:103], v[200:203]
    v_permlane16_swap_b32 v176, v178
    v_mfma_f32_16x16x32_bf16 v[196:199], v[36:39], v[96:99], v[196:199]
    ds_read_b64_tr_b16 v[52:53], v13 offset:24576
    ds_read_b64_tr_b16 v[54:55], v13 offset:26624
    v_mfma_f32_16x16x32_bf16 v[204:207], v[36:39], v[100:103], v[204:207]
    s_waitcnt lgkmcnt(4)
    v_permlane16_swap_b32 v177, v179
    v_mfma_f32_16x16x32_bf16 v[192:195], v[40:43], v[104:107], v[192:195]
    ds_read_b64_tr_b16 v[56:57], v12 offset:28672
    ds_read_b64_tr_b16 v[58:59], v12 offset:30720
    v_mfma_f32_16x16x32_bf16 v[200:203], v[40:43], v[108:111], v[200:203]
    buffer_store_dwordx4 v[176:179], v24, s[28:31], s5 offen offset:64 sc1
    v_mul_f32 v184, v35, v184
    v_mul_f32 v185, v35, v185
    v_mfma_f32_16x16x32_bf16 v[196:199], v[44:47], v[104:107], v[196:199]
    ds_read_b64_tr_b16 v[60:61], v13 offset:28672
    ds_read_b64_tr_b16 v[62:63], v13 offset:30720
    v_mfma_f32_16x16x32_bf16 v[204:207], v[44:47], v[108:111], v[204:207]
    s_waitcnt lgkmcnt(4)
    v_mul_f32 v186, v35, v186
    v_mul_f32 v187, v35, v187
    v_mfma_f32_16x16x32_bf16 v[192:195], v[48:51], v[112:115], v[192:195]
    ds_read_b64_tr_b16 v[20:21], v14 offset:0
    ds_read_b64_tr_b16 v[22:23], v14 offset:2048
    v_mfma_f32_16x16x32_bf16 v[200:203], v[48:51], v[116:119], v[200:203]
    v_mul_f32 v188, v35, v188
    v_mul_f32 v189, v35, v189
    v_mfma_f32_16x16x32_bf16 v[196:199], v[52:55], v[112:115], v[196:199]
    ds_read_b64_tr_b16 v[36:37], v15 offset:0
    ds_read_b64_tr_b16 v[38:39], v15 offset:2048
    v_mfma_f32_16x16x32_bf16 v[204:207], v[52:55], v[116:119], v[204:207]
    s_waitcnt lgkmcnt(4)
    v_mul_f32 v190, v35, v190
    v_mul_f32 v191, v35, v191
    v_mfma_f32_16x16x32_bf16 v[192:195], v[56:59], v[120:123], v[192:195]
    ds_read_b64_tr_b16 v[40:41], v14 offset:4096
    ds_read_b64_tr_b16 v[42:43], v14 offset:6144
    v_mfma_f32_16x16x32_bf16 v[200:203], v[56:59], v[124:127], v[200:203]
    v_cvt_pk_bf16_f32 v184, v184, v185
    v_cvt_pk_bf16_f32 v185, v186, v187
    v_mfma_f32_16x16x32_bf16 v[196:199], v[60:63], v[120:123], v[196:199]
    ds_read_b64_tr_b16 v[44:45], v15 offset:4096
    ds_read_b64_tr_b16 v[46:47], v15 offset:6144
    v_mfma_f32_16x16x32_bf16 v[204:207], v[60:63], v[124:127], v[204:207]
    s_waitcnt lgkmcnt(4)
    v_cvt_pk_bf16_f32 v186, v188, v189
    v_cvt_pk_bf16_f32 v187, v190, v191
    v_mfma_f32_16x16x32_bf16 v[208:211], v[20:23], v[64:67], v[208:211]
    ds_read_b64_tr_b16 v[48:49], v14 offset:8192
    ds_read_b64_tr_b16 v[50:51], v14 offset:10240
    v_mfma_f32_16x16x32_bf16 v[216:219], v[20:23], v[68:71], v[216:219]
    v_permlane16_swap_b32 v184, v186
    v_mfma_f32_16x16x32_bf16 v[212:215], v[36:39], v[64:67], v[212:215]
    ds_read_b64_tr_b16 v[52:53], v15 offset:8192
    ds_read_b64_tr_b16 v[54:55], v15 offset:10240
    v_mfma_f32_16x16x32_bf16 v[220:223], v[36:39], v[68:71], v[220:223]
    s_waitcnt lgkmcnt(4)
    v_permlane16_swap_b32 v185, v187
    v_mfma_f32_16x16x32_bf16 v[208:211], v[40:43], v[72:75], v[208:211]
    ds_read_b64_tr_b16 v[56:57], v14 offset:12288
    ds_read_b64_tr_b16 v[58:59], v14 offset:14336
    v_mfma_f32_16x16x32_bf16 v[216:219], v[40:43], v[76:79], v[216:219]
    buffer_store_dwordx4 v[184:187], v24, s[28:31], s9 offen offset:64 sc1
    v_mul_f32 v192, v34, v192
    v_mul_f32 v193, v34, v193
    v_mfma_f32_16x16x32_bf16 v[212:215], v[44:47], v[72:75], v[212:215]
    ds_read_b64_tr_b16 v[60:61], v15 offset:12288
    ds_read_b64_tr_b16 v[62:63], v15 offset:14336
    v_mfma_f32_16x16x32_bf16 v[220:223], v[44:47], v[76:79], v[220:223]
    s_waitcnt lgkmcnt(4)
    v_mul_f32 v194, v34, v194
    v_mul_f32 v195, v34, v195
    v_mfma_f32_16x16x32_bf16 v[208:211], v[48:51], v[80:83], v[208:211]
    ds_read_b64_tr_b16 v[20:21], v14 offset:16384
    ds_read_b64_tr_b16 v[22:23], v14 offset:18432
    v_mfma_f32_16x16x32_bf16 v[216:219], v[48:51], v[84:87], v[216:219]
    v_mul_f32 v196, v34, v196
    v_mul_f32 v197, v34, v197
    v_mfma_f32_16x16x32_bf16 v[212:215], v[52:55], v[80:83], v[212:215]
    ds_read_b64_tr_b16 v[36:37], v15 offset:16384
    ds_read_b64_tr_b16 v[38:39], v15 offset:18432
    v_mfma_f32_16x16x32_bf16 v[220:223], v[52:55], v[84:87], v[220:223]
    s_waitcnt lgkmcnt(4)
    v_mul_f32 v198, v34, v198
    v_mul_f32 v199, v34, v199
    v_mfma_f32_16x16x32_bf16 v[208:211], v[56:59], v[88:91], v[208:211]
    ds_read_b64_tr_b16 v[40:41], v14 offset:20480
    ds_read_b64_tr_b16 v[42:43], v14 offset:22528
    v_mfma_f32_16x16x32_bf16 v[216:219], v[56:59], v[92:95], v[216:219]
    v_cvt_pk_bf16_f32 v192, v192, v193
    v_cvt_pk_bf16_f32 v193, v194, v195
    v_mfma_f32_16x16x32_bf16 v[212:215], v[60:63], v[88:91], v[212:215]
    ds_read_b64_tr_b16 v[44:45], v15 offset:20480
    ds_read_b64_tr_b16 v[46:47], v15 offset:22528
    v_mfma_f32_16x16x32_bf16 v[220:223], v[60:63], v[92:95], v[220:223]
    s_waitcnt lgkmcnt(4)
    v_cvt_pk_bf16_f32 v194, v196, v197
    v_cvt_pk_bf16_f32 v195, v198, v199
    v_mfma_f32_16x16x32_bf16 v[208:211], v[20:23], v[96:99], v[208:211]
    ds_read_b64_tr_b16 v[48:49], v14 offset:24576
    ds_read_b64_tr_b16 v[50:51], v14 offset:26624
    v_mfma_f32_16x16x32_bf16 v[216:219], v[20:23], v[100:103], v[216:219]
    v_permlane16_swap_b32 v192, v194
    v_mfma_f32_16x16x32_bf16 v[212:215], v[36:39], v[96:99], v[212:215]
    ds_read_b64_tr_b16 v[52:53], v15 offset:24576
    ds_read_b64_tr_b16 v[54:55], v15 offset:26624
    v_mfma_f32_16x16x32_bf16 v[220:223], v[36:39], v[100:103], v[220:223]
    s_waitcnt lgkmcnt(4)
    v_permlane16_swap_b32 v193, v195
    v_mfma_f32_16x16x32_bf16 v[208:211], v[40:43], v[104:107], v[208:211]
    ds_read_b64_tr_b16 v[56:57], v14 offset:28672
    ds_read_b64_tr_b16 v[58:59], v14 offset:30720
    v_mfma_f32_16x16x32_bf16 v[216:219], v[40:43], v[108:111], v[216:219]
    buffer_store_dwordx4 v[192:195], v24, s[28:31], s6 offen offset:0 sc1
    v_mul_f32 v200, v35, v200
    v_mul_f32 v201, v35, v201
    v_mfma_f32_16x16x32_bf16 v[212:215], v[44:47], v[104:107], v[212:215]
    ds_read_b64_tr_b16 v[60:61], v15 offset:28672
    ds_read_b64_tr_b16 v[62:63], v15 offset:30720
    v_mfma_f32_16x16x32_bf16 v[220:223], v[44:47], v[108:111], v[220:223]
    s_waitcnt lgkmcnt(4)
    v_mul_f32 v202, v35, v202
    v_mul_f32 v203, v35, v203
    v_mfma_f32_16x16x32_bf16 v[208:211], v[48:51], v[112:115], v[208:211]
    v_mul_f32 v204, v35, v204
    v_mul_f32 v205, v35, v205
    v_mfma_f32_16x16x32_bf16 v[216:219], v[48:51], v[116:119], v[216:219]
    s_barrier
    ds_read_b64_tr_b16 v[20:21], v12 offset:32768
    ds_read_b64_tr_b16 v[22:23], v12 offset:34816
    v_mfma_f32_16x16x32_bf16 v[212:215], v[52:55], v[112:115], v[212:215]
    ds_read_b64_tr_b16 v[36:37], v13 offset:32768
    ds_read_b64_tr_b16 v[38:39], v13 offset:34816
    v_mfma_f32_16x16x32_bf16 v[220:223], v[52:55], v[116:119], v[220:223]
    s_waitcnt lgkmcnt(4)
    v_mul_f32 v206, v35, v206
    v_mul_f32 v207, v35, v207
    v_mfma_f32_16x16x32_bf16 v[208:211], v[56:59], v[120:123], v[208:211]
    ds_read_b64_tr_b16 v[40:41], v12 offset:36864
    ds_read_b64_tr_b16 v[42:43], v12 offset:38912
    v_mfma_f32_16x16x32_bf16 v[216:219], v[56:59], v[124:127], v[216:219]
    v_cvt_pk_bf16_f32 v200, v200, v201
    v_cvt_pk_bf16_f32 v201, v202, v203
    v_mfma_f32_16x16x32_bf16 v[212:215], v[60:63], v[120:123], v[212:215]
    ds_read_b64_tr_b16 v[44:45], v13 offset:36864
    ds_read_b64_tr_b16 v[46:47], v13 offset:38912
    v_mfma_f32_16x16x32_bf16 v[220:223], v[60:63], v[124:127], v[220:223]
    s_waitcnt lgkmcnt(4)
    v_cvt_pk_bf16_f32 v202, v204, v205
    v_cvt_pk_bf16_f32 v203, v206, v207
    v_mfma_f32_16x16x32_bf16 v[224:227], v[20:23], v[64:67], v[224:227]
    ds_read_b64_tr_b16 v[48:49], v12 offset:40960
    ds_read_b64_tr_b16 v[50:51], v12 offset:43008
    v_mfma_f32_16x16x32_bf16 v[232:235], v[20:23], v[68:71], v[232:235]
    v_permlane16_swap_b32 v200, v202
    v_mfma_f32_16x16x32_bf16 v[228:231], v[36:39], v[64:67], v[228:231]
    ds_read_b64_tr_b16 v[52:53], v13 offset:40960
    ds_read_b64_tr_b16 v[54:55], v13 offset:43008
    v_mfma_f32_16x16x32_bf16 v[236:239], v[36:39], v[68:71], v[236:239]
    s_waitcnt lgkmcnt(4)
    v_permlane16_swap_b32 v201, v203
    v_mfma_f32_16x16x32_bf16 v[224:227], v[40:43], v[72:75], v[224:227]
    ds_read_b64_tr_b16 v[56:57], v12 offset:45056
    ds_read_b64_tr_b16 v[58:59], v12 offset:47104
    v_mfma_f32_16x16x32_bf16 v[232:235], v[40:43], v[76:79], v[232:235]
    buffer_store_dwordx4 v[200:203], v24, s[28:31], s10 offen offset:0 sc1
    v_mul_f32 v208, v34, v208
    v_mul_f32 v209, v34, v209
    v_mfma_f32_16x16x32_bf16 v[228:231], v[44:47], v[72:75], v[228:231]
    ds_read_b64_tr_b16 v[60:61], v13 offset:45056
    ds_read_b64_tr_b16 v[62:63], v13 offset:47104
    v_mfma_f32_16x16x32_bf16 v[236:239], v[44:47], v[76:79], v[236:239]
    s_waitcnt lgkmcnt(4)
    v_mul_f32 v210, v34, v210
    v_mul_f32 v211, v34, v211
    v_mfma_f32_16x16x32_bf16 v[224:227], v[48:51], v[80:83], v[224:227]
    ds_read_b64_tr_b16 v[20:21], v12 offset:49152
    ds_read_b64_tr_b16 v[22:23], v12 offset:51200
    v_mfma_f32_16x16x32_bf16 v[232:235], v[48:51], v[84:87], v[232:235]
    v_mul_f32 v212, v34, v212
    v_mul_f32 v213, v34, v213
    v_mfma_f32_16x16x32_bf16 v[228:231], v[52:55], v[80:83], v[228:231]
    ds_read_b64_tr_b16 v[36:37], v13 offset:49152
    ds_read_b64_tr_b16 v[38:39], v13 offset:51200
    v_mfma_f32_16x16x32_bf16 v[236:239], v[52:55], v[84:87], v[236:239]
    s_waitcnt lgkmcnt(4)
    v_mul_f32 v214, v34, v214
    v_mul_f32 v215, v34, v215
    v_mfma_f32_16x16x32_bf16 v[224:227], v[56:59], v[88:91], v[224:227]
    ds_read_b64_tr_b16 v[40:41], v12 offset:53248
    ds_read_b64_tr_b16 v[42:43], v12 offset:55296
    v_mfma_f32_16x16x32_bf16 v[232:235], v[56:59], v[92:95], v[232:235]
    v_cvt_pk_bf16_f32 v208, v208, v209
    v_cvt_pk_bf16_f32 v209, v210, v211
    v_mfma_f32_16x16x32_bf16 v[228:231], v[60:63], v[88:91], v[228:231]
    ds_read_b64_tr_b16 v[44:45], v13 offset:53248
    ds_read_b64_tr_b16 v[46:47], v13 offset:55296
    v_mfma_f32_16x16x32_bf16 v[236:239], v[60:63], v[92:95], v[236:239]
    s_waitcnt lgkmcnt(4)
    v_cvt_pk_bf16_f32 v210, v212, v213
    v_cvt_pk_bf16_f32 v211, v214, v215
    v_mfma_f32_16x16x32_bf16 v[224:227], v[20:23], v[96:99], v[224:227]
    ds_read_b64_tr_b16 v[48:49], v12 offset:57344
    ds_read_b64_tr_b16 v[50:51], v12 offset:59392
    v_mfma_f32_16x16x32_bf16 v[232:235], v[20:23], v[100:103], v[232:235]
    v_permlane16_swap_b32 v208, v210
    v_mfma_f32_16x16x32_bf16 v[228:231], v[36:39], v[96:99], v[228:231]
    ds_read_b64_tr_b16 v[52:53], v13 offset:57344
    ds_read_b64_tr_b16 v[54:55], v13 offset:59392
    v_mfma_f32_16x16x32_bf16 v[236:239], v[36:39], v[100:103], v[236:239]
    s_waitcnt lgkmcnt(4)
    v_permlane16_swap_b32 v209, v211
    v_mfma_f32_16x16x32_bf16 v[224:227], v[40:43], v[104:107], v[224:227]
    ds_read_b64_tr_b16 v[56:57], v12 offset:61440
    ds_read_b64_tr_b16 v[58:59], v12 offset:63488
    v_mfma_f32_16x16x32_bf16 v[232:235], v[40:43], v[108:111], v[232:235]
    buffer_store_dwordx4 v[208:211], v24, s[28:31], s6 offen offset:64 sc1
    v_mul_f32 v216, v35, v216
    v_mul_f32 v217, v35, v217
    v_mfma_f32_16x16x32_bf16 v[228:231], v[44:47], v[104:107], v[228:231]
    ds_read_b64_tr_b16 v[60:61], v13 offset:61440
    ds_read_b64_tr_b16 v[62:63], v13 offset:63488
    v_mfma_f32_16x16x32_bf16 v[236:239], v[44:47], v[108:111], v[236:239]
    s_waitcnt lgkmcnt(4)
    v_mul_f32 v218, v35, v218
    v_mul_f32 v219, v35, v219
    v_mfma_f32_16x16x32_bf16 v[224:227], v[48:51], v[112:115], v[224:227]
    ds_read_b64_tr_b16 v[20:21], v14 offset:32768
    ds_read_b64_tr_b16 v[22:23], v14 offset:34816
    v_mfma_f32_16x16x32_bf16 v[232:235], v[48:51], v[116:119], v[232:235]
    v_mul_f32 v220, v35, v220
    v_mul_f32 v221, v35, v221
    v_mfma_f32_16x16x32_bf16 v[228:231], v[52:55], v[112:115], v[228:231]
    ds_read_b64_tr_b16 v[36:37], v15 offset:32768
    ds_read_b64_tr_b16 v[38:39], v15 offset:34816
    v_mfma_f32_16x16x32_bf16 v[236:239], v[52:55], v[116:119], v[236:239]
    s_waitcnt lgkmcnt(4)
    v_mul_f32 v222, v35, v222
    v_mul_f32 v223, v35, v223
    v_mfma_f32_16x16x32_bf16 v[224:227], v[56:59], v[120:123], v[224:227]
    ds_read_b64_tr_b16 v[40:41], v14 offset:36864
    ds_read_b64_tr_b16 v[42:43], v14 offset:38912
    v_mfma_f32_16x16x32_bf16 v[232:235], v[56:59], v[124:127], v[232:235]
    v_cvt_pk_bf16_f32 v216, v216, v217
    v_cvt_pk_bf16_f32 v217, v218, v219
    v_mfma_f32_16x16x32_bf16 v[228:231], v[60:63], v[120:123], v[228:231]
    ds_read_b64_tr_b16 v[44:45], v15 offset:36864
    ds_read_b64_tr_b16 v[46:47], v15 offset:38912
    v_mfma_f32_16x16x32_bf16 v[236:239], v[60:63], v[124:127], v[236:239]
    s_waitcnt lgkmcnt(4)
    v_cvt_pk_bf16_f32 v218, v220, v221
    v_cvt_pk_bf16_f32 v219, v222, v223
    v_mfma_f32_16x16x32_bf16 v[240:243], v[20:23], v[64:67], v[240:243]
    ds_read_b64_tr_b16 v[48:49], v14 offset:40960
    ds_read_b64_tr_b16 v[50:51], v14 offset:43008
    v_mfma_f32_16x16x32_bf16 v[248:251], v[20:23], v[68:71], v[248:251]
    v_permlane16_swap_b32 v216, v218
    v_mfma_f32_16x16x32_bf16 v[244:247], v[36:39], v[64:67], v[244:247]
    ds_read_b64_tr_b16 v[52:53], v15 offset:40960
    ds_read_b64_tr_b16 v[54:55], v15 offset:43008
    v_mfma_f32_16x16x32_bf16 v[252:255], v[36:39], v[68:71], v[252:255]
    s_waitcnt lgkmcnt(4)
    v_permlane16_swap_b32 v217, v219
    v_mfma_f32_16x16x32_bf16 v[240:243], v[40:43], v[72:75], v[240:243]
    ds_read_b64_tr_b16 v[56:57], v14 offset:45056
    ds_read_b64_tr_b16 v[58:59], v14 offset:47104
    v_mfma_f32_16x16x32_bf16 v[248:251], v[40:43], v[76:79], v[248:251]
    buffer_store_dwordx4 v[216:219], v24, s[28:31], s10 offen offset:64 sc1
    v_mul_f32 v224, v34, v224
    v_mul_f32 v225, v34, v225
    v_mul_f32 v226, v34, v226
    v_mfma_f32_16x16x32_bf16 v[244:247], v[44:47], v[72:75], v[244:247]
    ds_read_b64_tr_b16 v[60:61], v15 offset:45056
    ds_read_b64_tr_b16 v[62:63], v15 offset:47104
    v_mfma_f32_16x16x32_bf16 v[252:255], v[44:47], v[76:79], v[252:255]
    s_waitcnt lgkmcnt(4)
    v_mul_f32 v227, v34, v227
    v_mul_f32 v228, v34, v228
    v_mul_f32 v229, v34, v229
    v_mfma_f32_16x16x32_bf16 v[240:243], v[48:51], v[80:83], v[240:243]
    ds_read_b64_tr_b16 v[20:21], v14 offset:49152
    ds_read_b64_tr_b16 v[22:23], v14 offset:51200
    v_mfma_f32_16x16x32_bf16 v[248:251], v[48:51], v[84:87], v[248:251]
    v_mul_f32 v230, v34, v230
    v_mul_f32 v231, v34, v231
    v_cvt_pk_bf16_f32 v224, v224, v225
    v_mfma_f32_16x16x32_bf16 v[244:247], v[52:55], v[80:83], v[244:247]
    ds_read_b64_tr_b16 v[36:37], v15 offset:49152
    ds_read_b64_tr_b16 v[38:39], v15 offset:51200
    v_mfma_f32_16x16x32_bf16 v[252:255], v[52:55], v[84:87], v[252:255]
    s_waitcnt lgkmcnt(4)
    v_cvt_pk_bf16_f32 v225, v226, v227
    v_cvt_pk_bf16_f32 v226, v228, v229
    v_cvt_pk_bf16_f32 v227, v230, v231
    v_mfma_f32_16x16x32_bf16 v[240:243], v[56:59], v[88:91], v[240:243]
    ds_read_b64_tr_b16 v[40:41], v14 offset:53248
    ds_read_b64_tr_b16 v[42:43], v14 offset:55296
    v_mfma_f32_16x16x32_bf16 v[248:251], v[56:59], v[92:95], v[248:251]
    v_permlane16_swap_b32 v224, v226
    v_mfma_f32_16x16x32_bf16 v[244:247], v[60:63], v[88:91], v[244:247]
    ds_read_b64_tr_b16 v[44:45], v15 offset:53248
    ds_read_b64_tr_b16 v[46:47], v15 offset:55296
    v_mfma_f32_16x16x32_bf16 v[252:255], v[60:63], v[92:95], v[252:255]
    s_waitcnt lgkmcnt(4)
    v_permlane16_swap_b32 v225, v227
    v_mfma_f32_16x16x32_bf16 v[240:243], v[20:23], v[96:99], v[240:243]
    ds_read_b64_tr_b16 v[48:49], v14 offset:57344
    ds_read_b64_tr_b16 v[50:51], v14 offset:59392
    v_mfma_f32_16x16x32_bf16 v[248:251], v[20:23], v[100:103], v[248:251]
    buffer_store_dwordx4 v[224:227], v24, s[28:31], s7 offen offset:0 sc1
    v_mul_f32 v232, v35, v232
    v_mul_f32 v233, v35, v233
    v_mul_f32 v234, v35, v234
    v_mfma_f32_16x16x32_bf16 v[244:247], v[36:39], v[96:99], v[244:247]
    ds_read_b64_tr_b16 v[52:53], v15 offset:57344
    ds_read_b64_tr_b16 v[54:55], v15 offset:59392
    v_mfma_f32_16x16x32_bf16 v[252:255], v[36:39], v[100:103], v[252:255]
    s_waitcnt lgkmcnt(4)
    v_mul_f32 v235, v35, v235
    v_mul_f32 v236, v35, v236
    v_mul_f32 v237, v35, v237
    v_mfma_f32_16x16x32_bf16 v[240:243], v[40:43], v[104:107], v[240:243]
    ds_read_b64_tr_b16 v[56:57], v14 offset:61440
    ds_read_b64_tr_b16 v[58:59], v14 offset:63488
    v_mfma_f32_16x16x32_bf16 v[248:251], v[40:43], v[108:111], v[248:251]
    v_mul_f32 v238, v35, v238
    v_mul_f32 v239, v35, v239
    v_cvt_pk_bf16_f32 v232, v232, v233
    v_mfma_f32_16x16x32_bf16 v[244:247], v[44:47], v[104:107], v[244:247]
    ds_read_b64_tr_b16 v[60:61], v15 offset:61440
    ds_read_b64_tr_b16 v[62:63], v15 offset:63488
    v_mfma_f32_16x16x32_bf16 v[252:255], v[44:47], v[108:111], v[252:255]
    s_waitcnt lgkmcnt(4)
    v_cvt_pk_bf16_f32 v233, v234, v235
    v_cvt_pk_bf16_f32 v234, v236, v237
    v_cvt_pk_bf16_f32 v235, v238, v239
    v_mfma_f32_16x16x32_bf16 v[240:243], v[48:51], v[112:115], v[240:243]
    v_permlane16_swap_b32 v232, v234
    v_mfma_f32_16x16x32_bf16 v[248:251], v[48:51], v[116:119], v[248:251]
    v_mfma_f32_16x16x32_bf16 v[244:247], v[52:55], v[112:115], v[244:247]
    v_permlane16_swap_b32 v233, v235
    v_mfma_f32_16x16x32_bf16 v[252:255], v[52:55], v[116:119], v[252:255]
    s_waitcnt lgkmcnt(2)
    v_mfma_f32_16x16x32_bf16 v[240:243], v[56:59], v[120:123], v[240:243]
    buffer_store_dwordx4 v[232:235], v24, s[28:31], s11 offen offset:0 sc1
    v_mfma_f32_16x16x32_bf16 v[248:251], v[56:59], v[124:127], v[248:251]
    s_waitcnt lgkmcnt(0)
    v_mfma_f32_16x16x32_bf16 v[244:247], v[60:63], v[120:123], v[244:247]
    v_mfma_f32_16x16x32_bf16 v[252:255], v[60:63], v[124:127], v[252:255]
    s_nop 2
    v_mul_f32 v240, v34, v240
    v_mul_f32 v241, v34, v241
    v_mul_f32 v242, v34, v242
    v_mul_f32 v243, v34, v243
    v_mul_f32 v244, v34, v244
    v_mul_f32 v245, v34, v245
    v_mul_f32 v246, v34, v246
    v_mul_f32 v247, v34, v247
    v_cvt_pk_bf16_f32 v240, v240, v241
    v_cvt_pk_bf16_f32 v241, v242, v243
    v_cvt_pk_bf16_f32 v242, v244, v245
    v_cvt_pk_bf16_f32 v243, v246, v247
    s_nop 0
    v_permlane16_swap_b32 v240, v242
    v_permlane16_swap_b32 v241, v243
    buffer_store_dwordx4 v[240:243], v24, s[28:31], s7 offen offset:64 sc1
    v_mul_f32 v248, v35, v248
    v_mul_f32 v249, v35, v249
    v_mul_f32 v250, v35, v250
    v_mul_f32 v251, v35, v251
    v_mul_f32 v252, v35, v252
    v_mul_f32 v253, v35, v253
    v_mul_f32 v254, v35, v254
    v_mul_f32 v255, v35, v255
    v_cvt_pk_bf16_f32 v248, v248, v249
    v_cvt_pk_bf16_f32 v249, v250, v251
    v_cvt_pk_bf16_f32 v250, v252, v253
    v_cvt_pk_bf16_f32 v251, v254, v255
    s_nop 0
    v_permlane16_swap_b32 v248, v250
    v_permlane16_swap_b32 v249, v251
    buffer_store_dwordx4 v[248:251], v24, s[28:31], s11 offen offset:64 sc1
L_fin:
L_end:
    s_endpgm
L_rescale:
    v_mov_b32 v34, v27
    v_mov_b32 v35, v27
    s_nop 15
    v_permlane16_swap_b32 v34, v35
    v_mul_f32 v128, v34, v128
    v_mul_f32 v129, v34, v129
    v_mul_f32 v130, v34, v130
    v_mul_f32 v131, v34, v131
    v_mul_f32 v132, v34, v132
    v_mul_f32 v133, v34, v133
    v_mul_f32 v134, v34, v134
    v_mul_f32 v135, v34, v135
    v_mul_f32 v136, v35, v136
    v_mul_f32 v137, v35, v137
    v_mul_f32 v138, v35, v138
    v_mul_f32 v139, v35, v139
    v_mul_f32 v140, v35, v140
    v_mul_f32 v141, v35, v141
    v_mul_f32 v142, v35, v142
    v_mul_f32 v143, v35, v143
    v_mul_f32 v144, v34, v144
    v_mul_f32 v145, v34, v145
    v_mul_f32 v146, v34, v146
    v_mul_f32 v147, v34, v147
    v_mul_f32 v148, v34, v148
    v_mul_f32 v149, v34, v149
    v_mul_f32 v150, v34, v150
    v_mul_f32 v151, v34, v151
    v_mul_f32 v152, v35, v152
    v_mul_f32 v153, v35, v153
    v_mul_f32 v154, v35, v154
    v_mul_f32 v155, v35, v155
    v_mul_f32 v156, v35, v156
    v_mul_f32 v157, v35, v157
    v_mul_f32 v158, v35, v158
    v_mul_f32 v159, v35, v159
    v_mul_f32 v160, v34, v160
    v_mul_f32 v161, v34, v161
    v_mul_f32 v162, v34, v162
    v_mul_f32 v163, v34, v163
    v_mul_f32 v164, v34, v164
    v_mul_f32 v165, v34, v165
    v_mul_f32 v166, v34, v166
    v_mul_f32 v167, v34, v167
    v_mul_f32 v168, v35, v168
    v_mul_f32 v169, v35, v169
    v_mul_f32 v170, v35, v170
    v_mul_f32 v171, v35, v171
    v_mul_f32 v172, v35, v172
    v_mul_f32 v173, v35, v173
    v_mul_f32 v174, v35, v174
    v_mul_f32 v175, v35, v175
    v_mul_f32 v176, v34, v176
    v_mul_f32 v177, v34, v177
    v_mul_f32 v178, v34, v178
    v_mul_f32 v179, v34, v179
    v_mul_f32 v180, v34, v180
    v_mul_f32 v181, v34, v181
    v_mul_f32 v182, v34, v182
    v_mul_f32 v183, v34, v183
    v_mul_f32 v184, v35, v184
    v_mul_f32 v185, v35, v185
    v_mul_f32 v186, v35, v186
    v_mul_f32 v187, v35, v187
    v_mul_f32 v188, v35, v188
    v_mul_f32 v189, v35, v189
    v_mul_f32 v190, v35, v190
    v_mul_f32 v191, v35, v191
    v_mul_f32 v192, v34, v192
    v_mul_f32 v193, v34, v193
    v_mul_f32 v194, v34, v194
    v_mul_f32 v195, v34, v195
    v_mul_f32 v196, v34, v196
    v_mul_f32 v197, v34, v197
    v_mul_f32 v198, v34, v198
    v_mul_f32 v199, v34, v199
    v_mul_f32 v200, v35, v200
    v_mul_f32 v201, v35, v201
    v_mul_f32 v202, v35, v202
    v_mul_f32 v203, v35, v203
    v_mul_f32 v204, v35, v204
    v_mul_f32 v205, v35, v205
    v_mul_f32 v206, v35, v206
    v_mul_f32 v207, v35, v207
    v_mul_f32 v208, v34, v208
    v_mul_f32 v209, v34, v209
    v_mul_f32 v210, v34, v210
    v_mul_f32 v211, v34, v211
    v_mul_f32 v212, v34, v212
    v_mul_f32 v213, v34, v213
    v_mul_f32 v214, v34, v214
    v_mul_f32 v215, v34, v215
    v_mul_f32 v216, v35, v216
    v_mul_f32 v217, v35, v217
    v_mul_f32 v218, v35, v218
    v_mul_f32 v219, v35, v219
    v_mul_f32 v220, v35, v220
    v_mul_f32 v221, v35, v221
    v_mul_f32 v222, v35, v222
    v_mul_f32 v223, v35, v223
    v_mul_f32 v224, v34, v224
    v_mul_f32 v225, v34, v225
    v_mul_f32 v226, v34, v226
    v_mul_f32 v227, v34, v227
    v_mul_f32 v228, v34, v228
    v_mul_f32 v229, v34, v229
    v_mul_f32 v230, v34, v230
    v_mul_f32 v231, v34, v231
    v_mul_f32 v232, v35, v232
    v_mul_f32 v233, v35, v233
    v_mul_f32 v234, v35, v234
    v_mul_f32 v235, v35, v235
    v_mul_f32 v236, v35, v236
    v_mul_f32 v237, v35, v237
    v_mul_f32 v238, v35, v238
    v_mul_f32 v239, v35, v239
    v_mul_f32 v240, v34, v240
    v_mul_f32 v241, v34, v241
    v_mul_f32 v242, v34, v242
    v_mul_f32 v243, v34, v243
    v_mul_f32 v244, v34, v244
    v_mul_f32 v245, v34, v245
    v_mul_f32 v246, v34, v246
    v_mul_f32 v247, v34, v247
    v_mul_f32 v248, v35, v248
    v_mul_f32 v249, v35, v249
    v_mul_f32 v250, v35, v250
    v_mul_f32 v251, v35, v251
    v_mul_f32 v252, v35, v252
    v_mul_f32 v253, v35, v253
    v_mul_f32 v254, v35, v254
    v_mul_f32 v255, v35, v255
    s_nop 1
    s_branch L_resc_back
L_codeend:

.section .rodata,"a"
.p2align 6
.amdhsa_kernel standalone__gqa_softmax__near_ridge_kernel
  .amdhsa_next_free_vgpr 256
  .amdhsa_next_free_sgpr 102
  .amdhsa_accum_offset 256
  .amdhsa_group_segment_fixed_size 0
  .amdhsa_kernarg_size 48
  .amdhsa_user_sgpr_count 2
  .amdhsa_user_sgpr_kernarg_segment_ptr 1
  .amdhsa_system_sgpr_workgroup_id_x 1
.end_amdhsa_kernel
```
